```python
import torch

def _softmax(x, axis=-1):
    return torch.softmax(x, dim=axis)

def _gelu(x):
    return torch.nn.functional.gelu(x, approximate='tanh')

def _silu(x):
    return torch.nn.functional.silu(x)

def _sigmoid(x):
    return torch.sigmoid(x)

def _layernorm(x, axis=-1, eps=1e-05):
    m = x.mean(dim=axis, keepdim=True)
    v = x.var(dim=axis, keepdim=True, unbiased=False)
    return (x - m) / torch.sqrt(v + eps)

def _scatter_add(tgt, idx, src, axis=0):
    return tgt.clone().index_add_(axis, idx, src)

def _segment_sum(src, seg, n):
    out = torch.zeros((n,) + src.shape[1:], dtype=src.dtype)
    return out.index_add_(0, seg, src)

def _pad(x, pw):
    flat = tuple((v for pair in reversed(pw) for v in pair))
    return torch.nn.functional.pad(x, flat)
kernel_name = 'adaLN_cond__sliding_block_cached__mixer_channel_mlp__decode'

def setup_inputs():

    _w = lambda a: (lambda t: t.to(torch.bfloat16) if t.is_floating_point() else t)(torch.as_tensor(a))

    def _A_setup():
        B, Sq, D = (2, 1, 512)
        Hq, Hkv, Sk, Dh = (32, 8, 8192, 128)
        assert Hq % Hkv == 0, (Hq, Hkv)
        return {'x': _w((lambda *s: torch.randn(*s, dtype=torch.bfloat16) * 0.1)(B, Sq, D)), 'k_cache': _w((lambda *s: torch.randn(*s, dtype=torch.bfloat16) * 0.8)(B, Hkv, Sk, Dh)), 'v_cache': _w((lambda *s: torch.randn(*s, dtype=torch.bfloat16) * 0.8)(B, Hkv, Sk, Dh)), 'wq': _w((lambda *s: torch.randn(*s, dtype=torch.bfloat16) * 0.8)(D, Hq * Dh) * D ** (-0.5)), 'wo': _w((lambda *s: torch.randn(*s, dtype=torch.bfloat16) * 0.8)(Hq * Dh, D) * (Hq * Dh) ** (-0.5))}
    _A_in = _A_setup()

    def _B_setup():
        B, S, D, F = (2, 1, 512, 1792)
        return {'x': _w((lambda *s: torch.randn(*s, dtype=torch.bfloat16) * 0.1)(B, S, D)), 'w1': _w((lambda *s: torch.randn(*s, dtype=torch.bfloat16) * 3.2)(D, F) * D ** (-0.5)), 'b1': _w((lambda *s: torch.randn(*s, dtype=torch.bfloat16) * 3.2)(F)), 'w2': _w((lambda *s: torch.randn(*s, dtype=torch.bfloat16) * 3.2)(F, D) * F ** (-0.5)), 'b2': _w((lambda *s: torch.randn(*s, dtype=torch.bfloat16) * 3.2)(D))}
    _B_in = _B_setup()
    return {'A_x': _A_in['x'], 'A_k_cache': _A_in['k_cache'], 'A_v_cache': _A_in['v_cache'], 'A_wq': _A_in['wq'], 'A_wo': _A_in['wo'], 'B_x': _B_in['x'], 'B_w1': _B_in['w1'], 'B_b1': _B_in['b1'], 'B_w2': _B_in['w2'], 'B_b2': _B_in['b2'], 'c': _w((lambda *s: torch.randn(*s, dtype=torch.bfloat16) * 0.4)(2, 512) * 8.0), 'w_mod': _w((lambda *s: torch.randn(*s, dtype=torch.bfloat16) * 0.4)(512, 6 * 512) * 512 ** (-0.5) * 8.0)}

def reference(A_x, A_k_cache, A_v_cache, A_wq, A_wo, B_x, B_w1, B_b1, B_w2, B_b2, c, w_mod):

    def _A_ref(x, k_cache, v_cache, wq, wo):
        B, Sq, D = x.shape
        Hq, Dh = (32, 128)
        Hkv, Sk = (k_cache.shape[1], k_cache.shape[2])
        W = min(4096, max(256, Sk // 4))
        rep = Hq // Hkv
        q = (lambda x, *d: x.permute(*d))((x @ wq).reshape(B, Sq, Hq, Dh), 0, 2, 1, 3)
        k = (lambda x, n, axis: torch.repeat_interleave(x, n, dim=axis))(k_cache[:, :, Sk - W:, :], rep, axis=1)
        v = (lambda x, n, axis: torch.repeat_interleave(x, n, dim=axis))(v_cache[:, :, Sk - W:, :], rep, axis=1)
        scores = torch.einsum('bhqd,bhkd->bhqk', q, k) * Dh ** (-0.5)
        p = _softmax(scores, axis=-1)
        o = torch.einsum('bhqk,bhkd->bhqd', p, v)
        return (lambda x, *d: x.permute(*d))(o, 0, 2, 1, 3).reshape(B, Sq, Hq * Dh) @ wo

    def _B_ref(x, w1, b1, w2, b2):
        y = _layernorm(x, axis=-1)
        h = _gelu(torch.einsum('bsd,df->bsf', y, w1) + b1)
        return torch.einsum('bsf,fd->bsd', h, w2) + b2
    x = A_x
    mod = (_silu(c) @ w_mod).reshape(c.shape[0], 6, 1, -1)
    sa, ca, ga, sb, cb, gb = (mod[:, 0].clone(), mod[:, 1].clone(), mod[:, 2].clone(), mod[:, 3].clone(), mod[:, 4].clone(), mod[:, 5].clone())
    h = _layernorm(x, axis=-1) * (1 + ca) + sa
    x = x + ga * _A_ref(h, A_k_cache, A_v_cache, A_wq, A_wo)
    h = _layernorm(x, axis=-1) * (1 + cb) + sb
    x = x + gb * _B_ref(h, B_w1, B_b1, B_w2, B_b2)
    return x
```

```asm
; @launch grid=(256,1,1) block=(640,1,1) lds=139520
.amdgcn_target "amdgcn-amd-amdhsa--gfx950"
.text
.globl adaLN_cond__sliding_block_cached__mixer_channel_mlp__decode_kernel
.p2align 8
.type adaLN_cond__sliding_block_cached__mixer_channel_mlp__decode_kernel,@function
adaLN_cond__sliding_block_cached__mixer_channel_mlp__decode_kernel:
L_start:
    s_load_dwordx16 s[20:35], s[0:1], 56
    s_load_dwordx16 s[4:19], s[0:1], 0
    v_lshrrev_b32 v1, 6, v0
    s_lshr_b32 s38, s2, 7
    v_readfirstlane_b32 s40, v1
    s_and_b32 s41, s2, 7
    s_cmp_gt_u32 s40, s38
    s_cbranch_scc0 L_P0
    s_sub_u32 s36, s2, s41
    s_add_u32 s36, s36, s40
    s_lshl_b32 s36, s36, 6
    s_getpc_b64 s[82:83]
    s_load_dword s80, s[82:83], s36
    s_branch L_other
L_P0:
    s_cmp_lg_u32 s38, 0
    s_cbranch_scc1 L_other
    s_mul_i32 s48, s41, 393200
    s_lshl4_add_u32 s48, s2, s48
    v_lshrrev_b32 v3, 3, v0
    v_mul_u32_u24 v3, 24448, v3
    v_lshl_add_u32 v4, v0, 4, s48
    v_add_u32 v3, v3, v4
    s_movk_i32 s48, 5056
    v_add_u32 v4, s48, v3
    v_add_u32 v5, s48, v4
    v_add_u32 v6, s48, v5
    s_lshl_b32 s48, s41, 7
    v_lshl_add_u32 v2, v0, 1, s48
    s_mov_b32 m0, 0
    s_waitcnt lgkmcnt(0)
    global_load_ushort v16, v2, s[26:27]
    global_load_ushort v17, v2, s[26:27] offset:1024
    global_load_lds_dwordx4 v3, s[28:29] offset:0 nt
    global_load_lds_dwordx4 v4, s[28:29] offset:1088 nt
    global_load_lds_dwordx4 v5, s[28:29] offset:2176 nt
    global_load_lds_dwordx4 v6, s[28:29] offset:3264 nt
    s_bitset1_b32 m0, 13
    s_add_u32 s48, s28, 196608
    s_addc_u32 s49, s29, 0
    global_load_lds_dwordx4 v3, s[48:49] offset:0 nt
    global_load_lds_dwordx4 v4, s[48:49] offset:1088 nt
    global_load_lds_dwordx4 v5, s[48:49] offset:2176 nt
    global_load_lds_dwordx4 v6, s[48:49] offset:3264 nt
    s_load_dword s32, s[34:35], 0
    s_lshr_b32 s42, s2, 3
L_P1:
    s_setprio 3
    s_mov_b32 s40, 8
    v_and_b32 v2, 3, v0
    v_bfe_u32 v11, v0, 2, 3
    v_lshl_add_u32 v2, v2, 3, v11
    v_and_or_b32 v2, v0, 32, v2
    v_lshlrev_b32 v2, 1, v2
    v_add_u32 v2, 131072, v2
    v_lshrrev_b32 v11, 4, v0
    v_mul_u32_u24 v11, 1088, v11
    v_bfe_u32 v12, v0, 2, 2
    v_lshl_add_u32 v11, v12, 7, v11
    v_and_b32 v12, 3, v0
    v_lshl_add_u32 v11, v12, 3, v11
    v_add_u32 v11, 0, v11
    s_mov_b32 s48, 131072
    v_and_b32 v15, 1, v0
    v_mul_u32_u24 v15, 128, v15
    v_and_b32 v18, 48, v0
    v_add3_u32 v15, v15, v18, s48
    s_lshr_b32 s47, s42, 3
    s_and_b32 s100, s42, 7
    s_lshl_b32 s48, s47, 15
    s_lshl_b32 s49, s100, 11
    s_add_u32 s48, s48, s49
    s_lshl_b32 s49, s41, 7
    s_add_u32 s48, s48, s49
    s_add_u32 s48, s48, 1376256
    v_and_b32 v10, 1, v0
    v_mul_u32_u24 v10, 16384, v10
    v_and_b32 v18, 2, v0
    v_lshl_add_u32 v10, v18, 18, v10
    v_and_b32 v18, 48, v0
    v_add3_u32 v10, v10, v18, s48
    s_waitcnt vmcnt(8)
    v_lshlrev_b32 v16, 16, v16
    v_lshlrev_b32 v17, 16, v17
    v_mul_f32 v28, 0xbfb8aa3b, v16
    v_mul_f32 v29, 0xbfb8aa3b, v17
    v_exp_f32 v28, v28
    v_exp_f32 v29, v29
    v_add_f32 v28, 1.0, v28
    v_add_f32 v29, 1.0, v29
    v_rcp_f32 v28, v28
    v_rcp_f32 v29, v29
    v_mul_f32 v16, v16, v28
    v_mul_f32 v17, v17, v29
    v_cvt_pk_bf16_f32 v16, v16, v17
    ds_write_b16 v2, v16
    ds_write_b16_d16_hi v2, v16 offset:128
    ds_read_b128 v[20:23], v15
    ds_read_b128 v[24:27], v15 offset:64
    s_waitcnt vmcnt(4)
    ds_read_b64_tr_b16 v[32:33], v11 offset:0
    ds_read_b64_tr_b16 v[34:35], v11 offset:512
    ds_read_b64_tr_b16 v[40:41], v11 offset:32
    ds_read_b64_tr_b16 v[42:43], v11 offset:544
    ds_read_b64_tr_b16 v[48:49], v11 offset:64
    ds_read_b64_tr_b16 v[50:51], v11 offset:576
    ds_read_b64_tr_b16 v[56:57], v11 offset:96
    ds_read_b64_tr_b16 v[58:59], v11 offset:608
    s_waitcnt lgkmcnt(0)
    v_mfma_f32_16x16x32_bf16 v[64:67], v[32:35], v[20:23], 0
    v_mfma_f32_16x16x32_bf16 v[68:71], v[40:43], v[20:23], 0
    v_mfma_f32_16x16x32_bf16 v[72:75], v[48:51], v[20:23], 0
    v_mfma_f32_16x16x32_bf16 v[76:79], v[56:59], v[20:23], 0
    s_waitcnt vmcnt(0)
    ds_read_b64_tr_b16 v[36:37], v11 offset:8192
    ds_read_b64_tr_b16 v[38:39], v11 offset:8704
    ds_read_b64_tr_b16 v[44:45], v11 offset:8224
    ds_read_b64_tr_b16 v[46:47], v11 offset:8736
    ds_read_b64_tr_b16 v[52:53], v11 offset:8256
    ds_read_b64_tr_b16 v[54:55], v11 offset:8768
    ds_read_b64_tr_b16 v[60:61], v11 offset:8288
    ds_read_b64_tr_b16 v[62:63], v11 offset:8800
    s_mov_b32 s37, 0xffff0000
    s_mov_b32 s39, 100000
    s_mov_b32 s44, 0x00030003
    s_mov_b32 s45, 0x00030003
    s_add_u32 s32, s32, 0x01010101
    s_mov_b32 s33, s32
    s_bfe_u32 s96, s32, 0x80000
    s_bfe_u32 s97, s32, 0x80008
    s_bfe_u32 s98, s32, 0x80010
    s_bfe_u32 s99, s32, 0x80018
    s_waitcnt lgkmcnt(0)
    v_mfma_f32_16x16x32_bf16 v[64:67], v[36:39], v[24:27], v[64:67]
    v_mfma_f32_16x16x32_bf16 v[68:71], v[44:47], v[24:27], v[68:71]
    v_mfma_f32_16x16x32_bf16 v[72:75], v[52:55], v[24:27], v[72:75]
    v_mfma_f32_16x16x32_bf16 v[76:79], v[60:63], v[24:27], v[76:79]
    s_mov_b64 exec, s[44:45]
    s_nop 3
    v_mov_b32_sdwa v64, s32 dst_sel:BYTE_0 dst_unused:UNUSED_PRESERVE src0_sel:BYTE_0
    v_mov_b32_sdwa v65, s32 dst_sel:BYTE_0 dst_unused:UNUSED_PRESERVE src0_sel:BYTE_1
    v_mov_b32_sdwa v66, s32 dst_sel:BYTE_0 dst_unused:UNUSED_PRESERVE src0_sel:BYTE_2
    v_mov_b32_sdwa v67, s32 dst_sel:BYTE_0 dst_unused:UNUSED_PRESERVE src0_sel:BYTE_3
    global_store_dwordx4 v10, v[64:67], s[34:35] offset:0 sc1
    v_mov_b32_sdwa v68, s32 dst_sel:BYTE_0 dst_unused:UNUSED_PRESERVE src0_sel:BYTE_0
    v_mov_b32_sdwa v69, s32 dst_sel:BYTE_0 dst_unused:UNUSED_PRESERVE src0_sel:BYTE_1
    v_mov_b32_sdwa v70, s32 dst_sel:BYTE_0 dst_unused:UNUSED_PRESERVE src0_sel:BYTE_2
    v_mov_b32_sdwa v71, s32 dst_sel:BYTE_0 dst_unused:UNUSED_PRESERVE src0_sel:BYTE_3
    global_store_dwordx4 v10, v[68:71], s[34:35] offset:64 sc1
    v_mov_b32_sdwa v72, s32 dst_sel:BYTE_0 dst_unused:UNUSED_PRESERVE src0_sel:BYTE_0
    v_mov_b32_sdwa v73, s32 dst_sel:BYTE_0 dst_unused:UNUSED_PRESERVE src0_sel:BYTE_1
    v_mov_b32_sdwa v74, s32 dst_sel:BYTE_0 dst_unused:UNUSED_PRESERVE src0_sel:BYTE_2
    v_mov_b32_sdwa v75, s32 dst_sel:BYTE_0 dst_unused:UNUSED_PRESERVE src0_sel:BYTE_3
    global_store_dwordx4 v10, v[72:75], s[34:35] offset:1024 sc1
    v_mov_b32_sdwa v76, s32 dst_sel:BYTE_0 dst_unused:UNUSED_PRESERVE src0_sel:BYTE_0
    v_mov_b32_sdwa v77, s32 dst_sel:BYTE_0 dst_unused:UNUSED_PRESERVE src0_sel:BYTE_1
    v_mov_b32_sdwa v78, s32 dst_sel:BYTE_0 dst_unused:UNUSED_PRESERVE src0_sel:BYTE_2
    v_mov_b32_sdwa v79, s32 dst_sel:BYTE_0 dst_unused:UNUSED_PRESERVE src0_sel:BYTE_3
    global_store_dwordx4 v10, v[76:79], s[34:35] offset:1088 sc1
    s_barrier
    s_lshl_b32 s48, s41, 11
    s_lshl_b32 s49, s42, 7
    s_add_u32 s48, s48, s49
    s_add_u32 s48, s48, 32768
    s_load_dword s81, s[34:35], s48
    s_sleep 34
    s_mov_b64 exec, -1
    s_setprio 0
    s_barrier
    s_endpgm
L_other:
    v_and_b32 v0, 63, v0
    s_bfe_u32 s42, s2, 0x40003
    v_lshrrev_b32 v2, 4, v0
    s_cmp_eq_u32 s38, 0
    s_cbranch_scc1 L_W0
L_A0:
    s_cmp_ge_u32 s38, 2
    s_cbranch_scc1 L_exit
    s_mov_b32 s46, s42
    s_lshr_b32 s50, s46, 3
    s_lshl_b32 s51, s50, 3
    s_add_u32 s51, s51, s41
    s_sub_u32 s40, s40, 2
    s_cbranch_scc0 L_C1
    s_and_b32 s47, s40, 1
    s_and_b32 s50, s46, 7
    s_lshl_b32 s55, s47, 13
    s_lshl_b32 s48, s51, 21
    s_lshl_b32 s49, s50, 10
    s_add_u32 s48, s48, s49
    s_lshl_b32 s49, s47, 16
    s_add_u32 s48, s48, s49
    s_add_u32 s48, s48, 1572864
    v_lshlrev_b32 v3, 1, v2
    v_xor_b32 v3, v3, v0
    v_lshl_add_u32 v32, v3, 4, s48
    v_xor_b32 v33, 9216, v32
    v_xor_b32 v34, 18560, v32
    v_xor_b32 v35, 27776, v32
    v_xor_b32 v36, 36880, v32
    v_xor_b32 v37, 46096, v32
    v_xor_b32 v38, 55440, v32
    v_xor_b32 v39, 64656, v32
    s_mov_b32 m0, s55
    s_lshl_b32 s52, s47, 2
    s_add_u32 s52, s52, 132336
    v_mov_b32 v7, s52
    v_mov_b32 v31, 1
    s_movk_i32 s53, 0x400
    s_waitcnt lgkmcnt(0)
    s_mov_b64 s[100:101], s[6:7]
    s_mov_b32 s52, 0
L_l0:
    s_waitcnt vmcnt(15)
    global_load_lds_dwordx4 v32, s[100:101] nt
    s_add_u32 m0, m0, s53
    s_waitcnt vmcnt(15)
    global_load_lds_dwordx4 v33, s[100:101] nt
    s_add_u32 m0, m0, s53
    s_waitcnt vmcnt(15)
    global_load_lds_dwordx4 v34, s[100:101] nt
    s_add_u32 m0, m0, s53
    s_waitcnt vmcnt(15)
    global_load_lds_dwordx4 v35, s[100:101] nt
    s_add_u32 m0, m0, s53
    s_waitcnt vmcnt(15)
    global_load_lds_dwordx4 v36, s[100:101] nt
    s_add_u32 m0, m0, s53
    s_waitcnt vmcnt(15)
    global_load_lds_dwordx4 v37, s[100:101] nt
    s_add_u32 m0, m0, s53
    s_waitcnt vmcnt(15)
    global_load_lds_dwordx4 v38, s[100:101] nt
    s_add_u32 m0, m0, s53
    s_waitcnt vmcnt(15)
    ds_write_b32 v7, v31
    global_load_lds_dwordx4 v39, s[100:101] nt
    s_add_u32 m0, m0, s53
    v_add_u32 v7, 8, v7
    s_add_u32 s100, s100, 131072
    s_addc_u32 s101, s101, 0
    s_add_u32 m0, m0, 8192
    s_lshr_b32 s52, m0, 14
    s_cmp_eq_u32 s52, 4
    s_cselect_b64 s[100:101], s[8:9], s[100:101]
    s_cmp_eq_u32 s52, 2
    s_cbranch_scc1 L_l2
    s_cmp_lg_u32 s52, 7
    s_cbranch_scc1 L_l3
L_l_gate:
    ds_read_b32 v12, v8 offset:208
    s_sub_u32 s39, s39, 1
    s_cbranch_scc1 L_end
    s_waitcnt lgkmcnt(0)
    v_cmp_ne_u32 vcc, 8, v12
    s_cbranch_vccz L_l3
    s_waitcnt vmcnt(8)
    ds_write_b32 v7, v31
    s_branch L_l_gate
L_l3:
    s_cmp_lt_u32 s52, 8
    s_cbranch_scc1 L_l0
    global_load_dword v16, v3, s[12:13]
    s_waitcnt vmcnt(9)
    ds_write_b32 v7, v31
    s_waitcnt vmcnt(1)
    ds_write_b32 v7, v31 offset:8
    s_endpgm
L_l2:
    s_add_u32 s40, s47, 8
    s_mov_b32 s39, 1000000
    v_mov_b32 v8, 132352
    s_lshr_b32 s54, s46, 3
    s_and_b32 s43, s46, 7
    s_lshl_b32 s48, s41, 19
    s_lshl_b32 s49, s54, 18
    s_add_u32 s48, s48, s49
    s_lshl_b32 s49, s43, 14
    s_add_u32 s48, s48, s49
    s_lshl_b32 s49, s47, 13
    s_add_u32 s48, s48, s49
    s_add_u32 s48, s48, 131072
    v_lshl_add_u32 v3, v0, 7, s48
    s_barrier
    s_branch L_l0
L_W0:
    s_sub_u32 s40, s40, 1
    s_cmp_eq_u32 s40, 8
    s_cbranch_scc1 L_exit
    s_lshr_b32 s51, s42, 2
    s_and_b32 s54, s42, 3
    s_bfe_u32 s48, s40, 0x10001
    s_lshl_b32 s48, s48, 2
    v_or_b32 v9, s48, v2
    v_lshlrev_b32 v9, 1, v9
    v_and_b32 v10, 15, v0
    v_xor_b32 v9, v9, v10
    v_lshlrev_b32 v10, 13, v2
    v_lshl_add_u32 v10, v9, 4, v10
    s_lshl_b32 s48, s51, 20
    s_lshl_b32 s49, s40, 15
    s_add_u32 s48, s48, s49
    s_lshl_b32 s49, s41, 10
    s_add_u32 s48, s48, s49
    s_lshl_b32 s49, s54, 8
    s_add_u32 s48, s48, s49
    v_add_u32 v10, s48, v10
    s_lshl_b32 s55, s40, 10
    s_add_u32 m0, s55, 16384
    s_lshr_b32 s50, s40, 2
    s_and_b32 s52, s40, 3
    s_lshl_b32 s48, s50, 10
    v_lshl_add_u32 v6, v0, 4, s48
    s_lshl_b32 s53, s51, 2
    s_add_u32 s53, s53, s52
    s_lshl_b32 s48, s50, 10
    s_lshl_b32 s49, s53, 6
    s_add_u32 s48, s48, s49
    v_and_b32 v5, 7, v0
    v_lshl_add_u32 v5, v5, 2, v2
    v_lshl_add_u32 v7, v5, 1, s48
    s_waitcnt lgkmcnt(0)
    s_load_dword s32, s[34:35], 0
    s_sleep 1
    global_load_dwordx4 v[20:23], v6, s[4:5]
    global_load_ushort v24, v7, s[4:5]
    global_load_lds_dwordx4 v10, s[10:11] nt
    v_add_u32 v10, 262144, v10
    s_add_u32 m0, s55, 24576
    s_nop 0
    global_load_lds_dwordx4 v10, s[10:11] nt
    v_add_u32 v10, 262144, v10
    s_add_u32 m0, s55, 32768
    s_nop 0
    global_load_lds_dwordx4 v10, s[10:11] nt
    v_add_u32 v10, 262144, v10
    s_add_u32 m0, s55, 40960
    s_barrier
    global_load_lds_dwordx4 v10, s[10:11] nt
L_W1:
    s_getreg_b32 s3, hwreg(HW_REG_XCC_ID, 0, 4)
    s_xor_b32 s3, s3, s41
    s_lshl_b32 s48, s50, 14
    s_lshl_b32 s49, s53, 10
    s_add_u32 s48, s48, s49
    s_add_u32 s48, s48, 1376256
    v_lshl_add_u32 v13, v0, 4, s48
    v_add_u32 v14, 0x8000, v13
    v_lshrrev_b32 v11, 4, v0
    v_bfe_u32 v15, v0, 2, 2
    v_lshl_add_u32 v11, v11, 3, v15
    v_mul_u32_u24 v11, 256, v11
    v_bfe_u32 v16, v0, 4, 1
    v_lshl_add_u32 v16, v16, 2, v15
    v_xor_b32 v16, s40, v16
    v_lshl_add_u32 v11, v16, 5, v11
    v_and_b32 v15, 3, v0
    v_lshl_add_u32 v11, v15, 3, v11
    v_add_u32 v11, 16384, v11
    s_mov_b32 s48, 131328
    v_and_b32 v12, 1, v0
    v_mul_u32_u24 v12, 320, v12
    v_and_b32 v15, 48, v0
    v_add3_u32 v12, v12, v15, s48
    s_mul_i32 s48, s50, 320
    s_lshl_b32 s49, s52, 6
    s_add_u32 s48, s48, s49
    s_add_u32 s48, s48, 131328
    v_lshl_add_u32 v2, v5, 1, s48
    s_lshl_b32 s48, s41, 13
    s_lshl_b32 s49, s54, 11
    s_add_u32 s48, s48, s49
    s_lshl_b32 s49, s50, 10
    s_add_u32 s48, s48, s49
    s_lshl_b32 s49, s51, 8
    s_add_u32 s48, s48, s49
    s_lshl_b32 s49, s52, 6
    s_add_u32 s48, s48, s49
    s_add_u32 s48, s48, 131072
    v_and_b32 v3, 1, v0
    v_mul_u32_u24 v3, 65536, v3
    v_and_b32 v4, 48, v0
    v_add3_u32 v3, v3, v4, s48
    s_lshl_b32 s48, s41, 11
    s_lshl_b32 s49, s42, 2
    s_add_u32 s48, s48, s49
    s_add_u32 s48, s48, 458752
    v_lshl_add_u32 v4, v0, 7, s48
    s_lshl_b32 s48, s41, 11
    s_lshl_b32 s49, s42, 2
    s_add_u32 s48, s48, s49
    s_add_u32 s48, s48, 65536
    v_lshl_add_u32 v8, v0, 6, s48
    s_add_u32 s48, s42, 1
    s_bitcmp1_b32 s48, 3
    s_cbranch_scc1 L_w_lr
    s_and_b32 s46, s42, 7
    s_and_b32 s100, s41, 1
    s_lshr_b32 s101, s41, 1
    v_lshrrev_b32 v26, 3, v0
    v_mul_u32_u24 v26, 6144, v26
    v_bfe_u32 v27, v0, 4, 1
    s_and_b32 s48, s40, 1
    s_lshl_b32 s48, s48, 1
    v_or_b32 v27, s48, v27
    v_lshlrev_b32 v27, 1, v27
    v_and_b32 v28, 7, v0
    v_xor_b32 v27, v27, v28
    v_lshl_add_u32 v26, v27, 4, v26
    s_mul_i32 s48, s100, 1572864
    s_mul_i32 s49, s40, 49152
    s_add_u32 s48, s48, s49
    s_lshl_b32 s49, s101, 10
    s_add_u32 s48, s48, s49
    s_lshl_b32 s49, s46, 7
    s_add_u32 s48, s48, s49
    s_add_u32 s48, s48, 2048
    v_add_u32 v26, s48, v26
    s_mov_b64 s[92:93], s[28:29]
    s_mov_b32 s94, 393216
    s_branch L_w_lj
L_w_lr:
    s_sub_u32 s46, s42, 7
    s_and_b32 s100, s46, 1
    s_lshr_b32 s101, s46, 1
    s_lshl_b32 s48, s41, 19
    s_lshl_b32 s49, s100, 18
    s_add_u32 s48, s48, s49
    s_lshl_b32 s49, s101, 8
    s_add_u32 s48, s48, s49
    s_lshl_b32 s49, s40, 12
    s_add_u32 s48, s48, s49
    v_lshl_add_u32 v26, v9, 4, s48
    v_lshrrev_b32 v27, 4, v0
    v_lshl_add_u32 v26, v27, 10, v26
    s_mov_b64 s[92:93], s[12:13]
    s_mov_b32 s94, 32768
L_w_lj:
    s_waitcnt vmcnt(4) lgkmcnt(0)
    s_mov_b32 s37, 0xffff0000
    s_mov_b32 s39, 100000
    s_mov_b32 s44, 0x00030003
    s_mov_b32 s45, 0x00030003
    s_add_u32 s32, s32, 0x01010101
    s_mov_b32 s33, s32
    s_bfe_u32 s96, s32, 0x80000
    s_bfe_u32 s97, s32, 0x80008
    s_bfe_u32 s98, s32, 0x80010
    s_bfe_u32 s99, s32, 0x80018
    v_mov_b32 v6, s32
    v_lshlrev_b32 v56, 16, v20
    v_and_b32 v57, s37, v20
    v_lshlrev_b32 v58, 16, v21
    v_and_b32 v59, s37, v21
    v_lshlrev_b32 v60, 16, v22
    v_and_b32 v61, s37, v22
    v_lshlrev_b32 v62, 16, v23
    v_and_b32 v63, s37, v23
    v_readfirstlane_b32 s14, v56
    s_nop 1
    v_pk_add_f32 v[40:41], v[56:57], s[14:15] op_sel_hi:[1,0] neg_lo:[0,1] neg_hi:[0,1]
    v_pk_add_f32 v[42:43], v[58:59], s[14:15] op_sel_hi:[1,0] neg_lo:[0,1] neg_hi:[0,1]
    v_pk_add_f32 v[44:45], v[60:61], s[14:15] op_sel_hi:[1,0] neg_lo:[0,1] neg_hi:[0,1]
    v_pk_add_f32 v[46:47], v[62:63], s[14:15] op_sel_hi:[1,0] neg_lo:[0,1] neg_hi:[0,1]
    v_pk_add_f32 v[48:49], v[40:41], v[42:43]
    v_pk_mul_f32 v[50:51], v[40:41], v[40:41]
    v_pk_add_f32 v[52:53], v[44:45], v[46:47]
    v_pk_fma_f32 v[50:51], v[42:43], v[42:43], v[50:51]
    v_pk_add_f32 v[48:49], v[48:49], v[52:53]
    v_pk_fma_f32 v[50:51], v[44:45], v[44:45], v[50:51]
    v_add_f32 v48, v48, v49
    v_pk_fma_f32 v[50:51], v[46:47], v[46:47], v[50:51]
    v_add_f32 v50, v50, v51
    v_add_f32_dpp v48, v48, v48 quad_perm:[1,0,3,2] row_mask:0xf bank_mask:0xf
    s_nop 0
    v_add_f32_dpp v50, v50, v50 quad_perm:[1,0,3,2] row_mask:0xf bank_mask:0xf
    v_add_f32_dpp v48, v48, v48 quad_perm:[2,3,0,1] row_mask:0xf bank_mask:0xf
    s_nop 0
    v_add_f32_dpp v50, v50, v50 quad_perm:[2,3,0,1] row_mask:0xf bank_mask:0xf
    v_add_f32_dpp v48, v48, v48 row_ror:4 row_mask:0xf bank_mask:0xf
    s_nop 0
    v_add_f32_dpp v50, v50, v50 row_ror:4 row_mask:0xf bank_mask:0xf
    v_add_f32_dpp v48, v48, v48 row_ror:8 row_mask:0xf bank_mask:0xf
    s_nop 0
    v_add_f32_dpp v50, v50, v50 row_ror:8 row_mask:0xf bank_mask:0xf
    v_add_f32_dpp v48, v48, v48 row_bcast:15 row_mask:0xa bank_mask:0xf
    s_nop 0
    v_add_f32_dpp v50, v50, v50 row_bcast:15 row_mask:0xa bank_mask:0xf
    v_add_f32_dpp v48, v48, v48 row_bcast:31 row_mask:0xc bank_mask:0xf
    s_nop 0
    v_add_f32_dpp v50, v50, v50 row_bcast:31 row_mask:0xc bank_mask:0xf
    v_mul_f32 v48, 0x3b000000, v48
    v_mul_f32 v50, 0x3b000000, v50
    v_fma_f32 v50, -v48, v48, v50
    v_max_f32 v50, 0, v50
    v_add_f32 v48, s14, v48
    v_cvt_pk_bf16_f32 v48, v48, v48
    v_and_b32 v48, s37, v48
    v_cvt_pk_bf16_f32 v50, v50, v50
    v_and_b32 v50, s37, v50
    v_add_f32 v50, 0x3727c5ac, v50
    v_cvt_pk_bf16_f32 v50, v50, v50
    v_and_b32 v50, s37, v50
    v_sqrt_f32 v50, v50
    s_nop 0
    v_cvt_pk_bf16_f32 v50, v50, v50
    v_and_b32 v50, s37, v50
    v_rcp_f32 v50, v50
    v_lshlrev_b32 v24, 16, v24
    v_readlane_b32 s14, v48, 63
    v_readlane_b32 s15, v50, 63
    s_nop 0
    v_subrev_f32 v24, s14, v24
    v_cvt_pk_bf16_f32 v24, v24, v24
    v_and_b32 v24, s37, v24
    v_mul_f32 v24, s15, v24
    v_cvt_pk_bf16_f32 v24, v24, v24
    v_and_b32 v24, s37, v24
    s_barrier
    global_load_dwordx4 v[32:35], v13, s[34:35] sc1
    global_load_dwordx4 v[36:39], v14, s[34:35] sc1
    s_waitcnt vmcnt(2)
    s_barrier
    ds_read_b64_tr_b16 v[64:65], v11 offset:0
    ds_read_b64_tr_b16 v[66:67], v11 offset:1024
    ds_read_b64_tr_b16 v[68:69], v11 offset:8192
    ds_read_b64_tr_b16 v[70:71], v11 offset:9216
    ds_read_b64_tr_b16 v[72:73], v11 offset:16384
    ds_read_b64_tr_b16 v[74:75], v11 offset:17408
    ds_read_b64_tr_b16 v[76:77], v11 offset:24576
    ds_read_b64_tr_b16 v[78:79], v11 offset:25600
    s_waitcnt vmcnt(0)
    s_branch L_w_chk
L_w_poll:
    global_load_dwordx4 v[32:35], v13, s[34:35] sc1
    global_load_dwordx4 v[36:39], v14, s[34:35] sc1
    s_waitcnt vmcnt(0)
L_w_chk:
    v_xor_b32 v32, s96, v32
    v_xor_b32 v33, s97, v33
    v_xor_b32 v34, s98, v34
    v_xor_b32 v35, s99, v35
    v_or3_b32 v40, v32, v33, v34
    v_or_b32 v40, v40, v35
    v_xor_b32 v36, s96, v36
    v_xor_b32 v37, s97, v37
    v_xor_b32 v38, s98, v38
    v_xor_b32 v39, s99, v39
    v_or3_b32 v40, v36, v37, v40
    v_or3_b32 v40, v38, v39, v40
    v_cmp_ne_u32_sdwa vcc, v40, 0 src0_sel:BYTE_0 src1_sel:DWORD
    s_cbranch_vccnz L_rt_1
    v_permlane32_swap_b32 v32, v34
    v_permlane32_swap_b32 v33, v35
    v_permlane32_swap_b32 v36, v38
    v_permlane32_swap_b32 v37, v39
    v_add_f32 v32, v32, v34
    v_add_f32 v33, v33, v35
    v_add_f32 v36, v36, v38
    v_add_f32 v37, v37, v39
    v_permlane16_swap_b32 v32, v33
    s_nop 0
    v_permlane16_swap_b32 v36, v37
    v_add_f32 v32, v32, v33
    v_add_f32 v36, v36, v37
    s_nop 0
    v_add_f32_dpp v32, v32, v32 row_ror:8 row_mask:0xf bank_mask:0xf
    v_add_f32_dpp v36, v36, v36 row_ror:8 row_mask:0xf bank_mask:0xf
    v_cvt_pk_bf16_f32 v36, v32, v36
    v_lshlrev_b32 v32, 16, v36
    v_and_b32 v36, s37, v36
    v_add_f32 v36, 1.0, v36
    v_cvt_pk_bf16_f32 v36, v36, v36
    v_and_b32 v36, s37, v36
    v_mul_f32 v24, v24, v36
    v_cvt_pk_bf16_f32 v24, v24, v24
    v_and_b32 v24, s37, v24
    v_add_f32 v24, v24, v32
    v_cvt_pk_bf16_f32 v24, v24, v24
    ds_write_b16 v2, v24
    s_waitcnt lgkmcnt(0)
    s_barrier
    ds_read_b128 v[32:35], v12 offset:0
    ds_read_b128 v[36:39], v12 offset:64
    ds_read_b128 v[40:43], v12 offset:128
    ds_read_b128 v[44:47], v12 offset:192
    s_cmp_lg_u32 s40, 7
    s_cbranch_scc1 L_w_nof
    s_mov_b32 exec_hi, 0
    s_cmp_lg_u32 s3, 0
    s_cbranch_scc1 L_w_nl
    global_store_dword v8, v6, s[34:35]
L_w_nl:
    s_mov_b64 exec, 0xffff
    global_store_dword v4, v6, s[34:35] sc1
    s_mov_b64 exec, -1
L_w_nof:
    s_waitcnt lgkmcnt(3)
    v_mfma_f32_16x16x32_bf16 v[28:31], v[64:67], v[32:35], 0
    s_waitcnt lgkmcnt(2)
    v_mfma_f32_16x16x32_bf16 v[28:31], v[68:71], v[36:39], v[28:31]
    s_waitcnt lgkmcnt(1)
    v_mfma_f32_16x16x32_bf16 v[28:31], v[72:75], v[40:43], v[28:31]
    s_waitcnt lgkmcnt(0)
    v_mfma_f32_16x16x32_bf16 v[28:31], v[76:79], v[44:47], v[28:31]
    s_mov_b64 exec, s[44:45]
    s_nop 6
    v_mov_b32_sdwa v28, s32 dst_sel:BYTE_0 dst_unused:UNUSED_PRESERVE src0_sel:BYTE_0
    v_mov_b32_sdwa v29, s32 dst_sel:BYTE_0 dst_unused:UNUSED_PRESERVE src0_sel:BYTE_1
    v_mov_b32_sdwa v30, s32 dst_sel:BYTE_0 dst_unused:UNUSED_PRESERVE src0_sel:BYTE_2
    v_mov_b32_sdwa v31, s32 dst_sel:BYTE_0 dst_unused:UNUSED_PRESERVE src0_sel:BYTE_3
    global_store_dwordx4 v3, v[28:31], s[34:35] sc1
    s_barrier
    s_mov_b64 exec, -1
    s_add_u32 s48, s42, 1
    s_bitcmp1_b32 s48, 3
    s_cbranch_scc1 L_roleR
    s_and_b32 s46, s42, 7
    s_and_b32 s53, s41, 1
    s_lshr_b32 s54, s41, 1
    s_lshl_b32 s48, s50, 10
    s_lshl_b32 s49, s53, 9
    s_add_u32 s48, s48, s49
    s_lshl_b32 s49, s52, 7
    s_add_u32 s48, s48, s49
    v_lshl_add_u32 v2, v0, 1, s48
    global_load_ushort v16, v2, s[26:27]
    s_mul_i32 s47, s41, 7
    s_add_u32 s47, s47, s42
    s_lshl_b32 s48, s40, 1
    v_xor_b32 v5, s48, v0
    s_lshl_b32 s43, s50, 13
    s_lshl_b32 s49, s52, 10
    s_add_u32 s43, s43, s49
    s_lshl_b32 s48, s47, 15
    s_add_u32 s48, s48, s43
    v_lshl_add_u32 v5, v5, 4, s48
    s_add_u32 m0, s55, 49152
    s_nop 0
    global_load_lds_dwordx4 v26, s[92:93] nt
    v_add_u32 v26, s94, v26
    s_add_u32 m0, s55, 57344
    s_nop 0
    global_load_lds_dwordx4 v26, s[92:93] nt
    v_add_u32 v26, s94, v26
    s_add_u32 m0, s55, 65536
    s_nop 0
    global_load_lds_dwordx4 v26, s[92:93] nt
    v_add_u32 v26, s94, v26
    s_add_u32 m0, s55, 73728
    s_nop 0
    global_load_lds_dwordx4 v26, s[92:93] nt
    v_add_u32 v26, s94, v26
    s_barrier
    s_cmp_eq_u32 s42, 15
    s_cbranch_scc1 L_mr_n2
    s_add_u32 m0, s43, 81920
    s_nop 0
    global_load_lds_dwordx4 v5, s[22:23] nt
    s_add_u32 m0, s43, 86016
    v_add_u32 v5, 4096, v5
    global_load_lds_dwordx4 v5, s[22:23] nt
L_mr_n2:
    s_lshl_b32 s48, s40, 7
    s_lshl_b32 s49, s50, 6
    s_add_u32 s48, s48, s49
    s_add_u32 s48, s48, 132096
    v_lshl_add_u32 v2, v0, 1, s48
    v_lshrrev_b32 v11, 4, v0
    v_bfe_u32 v12, v0, 2, 2
    v_lshl_add_u32 v11, v11, 3, v12
    v_mul_u32_u24 v11, 128, v11
    v_bfe_u32 v13, v0, 4, 1
    v_lshrrev_b32 v12, 1, v12
    v_lshl_add_u32 v13, v13, 1, v12
    v_xor_b32 v13, s52, v13
    v_lshl_add_u32 v11, v13, 5, v11
    v_and_b32 v12, 3, v0
    v_lshl_add_u32 v11, v12, 3, v11
    v_add_u32 v11, 49152, v11
    s_mov_b32 s48, 132096
    v_and_b32 v12, 1, v0
    v_mul_u32_u24 v12, 576, v12
    v_and_b32 v13, 48, v0
    v_add3_u32 v12, v12, v13, s48
    s_lshl_b32 s48, s54, 13
    s_lshl_b32 s49, s53, 11
    s_add_u32 s48, s48, s49
    s_lshl_b32 s49, s46, 8
    s_add_u32 s48, s48, s49
    s_lshl_b32 s49, s52, 6
    s_add_u32 s48, s48, s49
    s_add_u32 s48, s48, 393216
    v_and_b32 v13, 1, v0
    v_mul_u32_u24 v13, 4096, v13
    v_and_b32 v14, 48, v0
    v_add3_u32 v13, v13, v14, s48
    s_waitcnt vmcnt(4)
    v_lshlrev_b32 v16, 16, v16
    v_mul_f32 v17, 0xbfb8aa3b, v16
    v_exp_f32 v17, v17
    s_nop 0
    v_add_f32 v17, 1.0, v17
    v_rcp_f32 v17, v17
    s_nop 0
    v_mul_f32 v16, v16, v17
    v_cvt_pk_bf16_f32 v16, v16, v16
    ds_write_b16 v2, v16
    s_cmp_eq_u32 s42, 15
    s_cbranch_scc0 L_mr_w
    s_waitcnt vmcnt(0)
L_mr_w:
    s_waitcnt vmcnt(2) lgkmcnt(0)
    s_barrier
    s_cmp_ge_u32 s40, 4
    s_cbranch_scc1 L_mr_skip
    ds_read_b64_tr_b16 v[32:33], v11 offset:0
    ds_read_b64_tr_b16 v[34:35], v11 offset:512
    ds_read_b64_tr_b16 v[36:37], v11 offset:4096
    ds_read_b64_tr_b16 v[38:39], v11 offset:4608
    ds_read_b64_tr_b16 v[40:41], v11 offset:8192
    ds_read_b64_tr_b16 v[42:43], v11 offset:8704
    ds_read_b64_tr_b16 v[44:45], v11 offset:12288
    ds_read_b64_tr_b16 v[46:47], v11 offset:12800
    ds_read_b64_tr_b16 v[48:49], v11 offset:16384
    ds_read_b64_tr_b16 v[50:51], v11 offset:16896
    ds_read_b64_tr_b16 v[52:53], v11 offset:20480
    ds_read_b64_tr_b16 v[54:55], v11 offset:20992
    ds_read_b64_tr_b16 v[56:57], v11 offset:24576
    ds_read_b64_tr_b16 v[58:59], v11 offset:25088
    ds_read_b64_tr_b16 v[60:61], v11 offset:28672
    ds_read_b64_tr_b16 v[62:63], v11 offset:29184
    ds_read_b128 v[64:67], v12 offset:0
    ds_read_b128 v[68:71], v12 offset:64
    ds_read_b128 v[72:75], v12 offset:128
    ds_read_b128 v[76:79], v12 offset:192
    ds_read_b128 v[80:83], v12 offset:256
    ds_read_b128 v[84:87], v12 offset:320
    ds_read_b128 v[88:91], v12 offset:384
    ds_read_b128 v[92:95], v12 offset:448
    s_waitcnt lgkmcnt(0)
    v_mfma_f32_16x16x32_bf16 v[28:31], v[32:35], v[64:67], 0
    v_mfma_f32_16x16x32_bf16 v[28:31], v[36:39], v[68:71], v[28:31]
    v_mfma_f32_16x16x32_bf16 v[28:31], v[40:43], v[72:75], v[28:31]
    v_mfma_f32_16x16x32_bf16 v[28:31], v[44:47], v[76:79], v[28:31]
    v_mfma_f32_16x16x32_bf16 v[28:31], v[48:51], v[80:83], v[28:31]
    v_mfma_f32_16x16x32_bf16 v[28:31], v[52:55], v[84:87], v[28:31]
    v_mfma_f32_16x16x32_bf16 v[28:31], v[56:59], v[88:91], v[28:31]
    v_mfma_f32_16x16x32_bf16 v[28:31], v[60:63], v[92:95], v[28:31]
    s_nop 7
    v_mov_b32_sdwa v28, s32 dst_sel:BYTE_0 dst_unused:UNUSED_PRESERVE src0_sel:BYTE_0
    v_mov_b32_sdwa v29, s32 dst_sel:BYTE_0 dst_unused:UNUSED_PRESERVE src0_sel:BYTE_1
    v_mov_b32_sdwa v30, s32 dst_sel:BYTE_0 dst_unused:UNUSED_PRESERVE src0_sel:BYTE_2
    v_mov_b32_sdwa v31, s32 dst_sel:BYTE_0 dst_unused:UNUSED_PRESERVE src0_sel:BYTE_3
    s_mov_b64 exec, s[44:45]
    global_store_dwordx4 v13, v[28:31], s[34:35] sc1
    s_mov_b64 exec, -1
L_mr_skip:
    s_barrier
    s_cmp_eq_u32 s42, 15
    s_cbranch_scc1 L_end
    s_mov_b32 s46, s47
    s_add_u32 m0, s43, 98304
    v_add_u32 v5, 12288, v5
    global_load_lds_dwordx4 v5, s[22:23] nt
    s_add_u32 m0, s43, 102400
    v_add_u32 v5, 4096, v5
    global_load_lds_dwordx4 v5, s[22:23] nt
    v_lshrrev_b32 v2, 2, v0
    v_mul_u32_u24 v2, 3584, v2
    v_lshrrev_b32 v3, 5, v0
    v_lshlrev_b32 v3, 1, v3
    v_and_b32 v4, 3, v0
    v_xor_b32 v3, v3, v4
    v_lshl_add_u32 v2, v3, 4, v2
    s_mul_i32 s48, s40, 57344
    s_lshl_b32 s49, s46, 6
    s_add_u32 s48, s48, s49
    v_add_u32 v2, s48, v2
    s_add_u32 m0, s55, 0
    s_nop 0
    global_load_lds_dwordx4 v2, s[16:17] nt
    v_add_u32 v2, 458752, v2
    s_add_u32 m0, s55, 8192
    s_nop 0
    global_load_lds_dwordx4 v2, s[16:17] nt
    v_add_u32 v2, 458752, v2
    s_add_u32 m0, s55, 16384
    s_nop 0
    global_load_lds_dwordx4 v2, s[16:17] nt
    v_add_u32 v2, 458752, v2
    s_add_u32 m0, s55, 24576
    s_nop 0
    global_load_lds_dwordx4 v2, s[16:17] nt
    v_and_b32 v4, 7, v0
    v_lshrrev_b32 v5, 4, v0
    v_lshl_add_u32 v4, v5, 3, v4
    s_lshl_b32 s48, s46, 6
    v_lshl_add_u32 v5, v4, 1, s48
    global_load_ushort v16, v5, s[18:19]
    s_and_b32 s100, s40, 1
    s_bfe_u32 s101, s40, 0x10001
    v_lshrrev_b32 v11, 4, v0
    v_bfe_u32 v12, v0, 2, 2
    v_lshl_add_u32 v11, v11, 3, v12
    v_mul_u32_u24 v11, 64, v11
    v_bfe_u32 v13, v0, 4, 1
    v_xor_b32 v13, s100, v13
    v_lshl_add_u32 v11, v13, 5, v11
    v_and_b32 v12, 3, v0
    v_lshl_add_u32 v11, v12, 3, v11
    s_lshl_b32 s48, s101, 14
    v_add_u32 v11, s48, v11
    v_lshrrev_b32 v12, 4, v0
    v_bfe_u32 v13, v0, 2, 2
    v_lshl_add_u32 v12, v12, 3, v13
    v_lshlrev_b32 v12, 10, v12
    v_bfe_u32 v14, v0, 4, 1
    v_lshl_add_u32 v14, v14, 2, v13
    v_and_b32 v13, 3, v0
    s_lshl_b32 s48, s40, 2
    v_or_b32 v13, s48, v13
    v_xor_b32 v13, v13, v14
    v_lshl_add_u32 v12, v13, 5, v12
    v_add_u32 v12, 81920, v12
    s_lshl_b32 s48, s101, 9
    s_add_u32 s48, s48, 135168
    v_and_b32 v13, 1, v0
    v_mul_u32_u24 v13, 1088, v13
    v_and_b32 v14, 48, v0
    v_add3_u32 v13, v13, v14, s48
    s_lshl_b32 s48, s101, 8
    s_lshl_b32 s49, s100, 6
    s_add_u32 s48, s48, s49
    s_add_u32 s48, s48, 134144
    v_and_b32 v14, 1, v0
    v_mul_u32_u24 v14, 128, v14
    v_and_b32 v15, 48, v0
    v_add3_u32 v14, v14, v15, s48
    s_lshl_b32 s48, s101, 7
    s_lshl_b32 s49, s100, 6
    s_add_u32 s48, s48, s49
    s_add_u32 s48, s48, 134656
    v_add_u32 v17, s48, v15
    v_bfe_u32 v6, v0, 3, 1
    v_lshlrev_b32 v7, 7, v6
    v_lshl_add_u32 v7, v4, 2, v7
    v_add_u32 v7, 134144, v7
    v_lshlrev_b32 v8, 2, v4
    v_add_u32 v8, 134656, v8
    v_lshlrev_b32 v9, 3, v6
    v_add_u32 v9, 134912, v9
    s_lshl_b32 s48, s40, 15
    s_lshl_b32 s49, s46, 6
    s_add_u32 s48, s48, s49
    s_add_u32 s48, s48, 524288
    s_load_dword s92, s[34:35], 256
L_nc_2:
    s_waitcnt lgkmcnt(0)
    s_sub_u32 s92, s92, s32
    s_cmp_gt_u32 s92, 1
    s_cbranch_scc1 L_nc_2_r
    v_xor_b32 v5, s92, v6
    v_lshlrev_b32 v5, 13, v5
    v_and_b32 v10, 32, v0
    v_lshl_add_u32 v5, v10, 9, v5
    v_and_b32 v10, 16, v0
    v_lshl_add_u32 v5, v10, 8, v5
    v_and_b32 v10, 3, v0
    v_lshlrev_b32 v18, 4, v10
    v_add3_u32 v5, v5, v18, s48
    v_cmp_eq_u32 s[86:87], 1, v10
    v_cmp_eq_u32 s[88:89], 2, v10
    v_cmp_eq_u32 s[90:91], 3, v10
    v_mov_b32 v114, 0xc0135761
    s_lshl_b32 s48, s100, 12
    s_add_u32 s48, s48, 114688
    v_lshl_add_u32 v18, v0, 4, s48
    s_lshl_b32 s48, s100, 2
    s_add_u32 s48, s48, 134944
    v_mov_b32 v19, s48
    v_mov_b32 v10, 0
    ds_write_b32 v19, v10
    s_waitcnt lgkmcnt(0)
    s_cmp_lt_u32 s40, 2
    s_cbranch_scc1 L_m_ln
    s_waitcnt vmcnt(0)
    s_barrier
    ds_read_b64_tr_b16 v[96:97], v12 offset:0
    ds_read_b64_tr_b16 v[98:99], v12 offset:4096
    ds_read_b64_tr_b16 v[100:101], v12 offset:8
    ds_read_b64_tr_b16 v[102:103], v12 offset:4104
    ds_read_b64_tr_b16 v[104:105], v12 offset:16
    ds_read_b64_tr_b16 v[106:107], v12 offset:4112
    ds_read_b64_tr_b16 v[108:109], v12 offset:24
    ds_read_b64_tr_b16 v[110:111], v12 offset:4120
    v_lshlrev_b32 v16, 16, v16
    s_cmp_lt_u32 s40, 4
    s_cbranch_scc1 L_m_idle
    ds_read_b64_tr_b16 v[64:65], v11 offset:0
    ds_read_b64_tr_b16 v[66:67], v11 offset:256
    ds_read_b64_tr_b16 v[68:69], v11 offset:2048
    ds_read_b64_tr_b16 v[70:71], v11 offset:2304
    ds_read_b64_tr_b16 v[72:73], v11 offset:4096
    ds_read_b64_tr_b16 v[74:75], v11 offset:4352
    ds_read_b64_tr_b16 v[76:77], v11 offset:6144
    ds_read_b64_tr_b16 v[78:79], v11 offset:6400
    ds_read_b64_tr_b16 v[80:81], v11 offset:8192
    ds_read_b64_tr_b16 v[82:83], v11 offset:8448
    ds_read_b64_tr_b16 v[84:85], v11 offset:10240
    ds_read_b64_tr_b16 v[86:87], v11 offset:10496
    ds_read_b64_tr_b16 v[88:89], v11 offset:12288
    ds_read_b64_tr_b16 v[90:91], v11 offset:12544
    ds_read_b64_tr_b16 v[92:93], v11 offset:14336
    ds_read_b64_tr_b16 v[94:95], v11 offset:14592
    v_mov_b32 v32, 0x3f803f80
    v_mov_b32 v33, 0x3f803f80
    v_mov_b32 v34, 0x3f803f80
    v_mov_b32 v35, 0x3f803f80
    s_waitcnt lgkmcnt(0)
    s_nop 0
    v_mfma_f32_16x16x32_bf16 v[28:31], v[64:67], v[32:35], 0
    v_mfma_f32_16x16x32_bf16 v[28:31], v[68:71], v[32:35], v[28:31]
    v_mfma_f32_16x16x32_bf16 v[28:31], v[72:75], v[32:35], v[28:31]
    v_mfma_f32_16x16x32_bf16 v[28:31], v[76:79], v[32:35], v[28:31]
    v_mfma_f32_16x16x32_bf16 v[28:31], v[80:83], v[32:35], v[28:31]
    v_mfma_f32_16x16x32_bf16 v[28:31], v[84:87], v[32:35], v[28:31]
    v_mfma_f32_16x16x32_bf16 v[28:31], v[88:91], v[32:35], v[28:31]
    v_mfma_f32_16x16x32_bf16 v[28:31], v[92:95], v[32:35], v[28:31]
    s_nop 7
    ds_write_b128 v17, v[28:31]
    s_waitcnt lgkmcnt(0)
    s_barrier
    ds_read_b128 v[32:35], v13 offset:0
    ds_read_b128 v[36:39], v13 offset:64
    ds_read_b128 v[40:43], v13 offset:128
    ds_read_b128 v[44:47], v13 offset:192
    ds_read_b128 v[48:51], v13 offset:256
    ds_read_b128 v[52:55], v13 offset:320
    ds_read_b128 v[56:59], v13 offset:384
    ds_read_b128 v[60:63], v13 offset:448
    ds_read2_b32 v[20:21], v8 offset0:0 offset1:32
    s_waitcnt lgkmcnt(8)
    v_mfma_f32_16x16x32_bf16 v[28:31], v[64:67], v[32:35], 0
    s_waitcnt lgkmcnt(7)
    v_mfma_f32_16x16x32_bf16 v[28:31], v[68:71], v[36:39], v[28:31]
    s_waitcnt lgkmcnt(6)
    v_mfma_f32_16x16x32_bf16 v[28:31], v[72:75], v[40:43], v[28:31]
    s_waitcnt lgkmcnt(5)
    v_mfma_f32_16x16x32_bf16 v[28:31], v[76:79], v[44:47], v[28:31]
    s_waitcnt lgkmcnt(4)
    v_mfma_f32_16x16x32_bf16 v[28:31], v[80:83], v[48:51], v[28:31]
    s_waitcnt lgkmcnt(3)
    v_mfma_f32_16x16x32_bf16 v[28:31], v[84:87], v[52:55], v[28:31]
    s_waitcnt lgkmcnt(2)
    v_mfma_f32_16x16x32_bf16 v[28:31], v[88:91], v[56:59], v[28:31]
    s_waitcnt lgkmcnt(1)
    v_mfma_f32_16x16x32_bf16 v[28:31], v[92:95], v[60:63], v[28:31]
    s_mov_b64 exec, s[44:45]
    s_nop 6
    ds_write_b128 v14, v[28:31]
    s_mov_b64 exec, -1
    s_branch L_m_join
L_m_idle:
    s_lshl_b32 s48, s100, 12
    s_add_u32 s48, s48, 401408
    v_lshl_add_u32 v3, v0, 4, s48
L_m_poll1:
    global_load_dwordx4 v[20:23], v3, s[34:35] offset:0 sc1
    global_load_dwordx4 v[24:27], v3, s[34:35] offset:1024 sc1
    global_load_dwordx4 v[28:31], v3, s[34:35] offset:2048 sc1
    global_load_dwordx4 v[32:35], v3, s[34:35] offset:3072 sc1
    s_waitcnt vmcnt(3)
    v_xor_b32 v20, s96, v20
    v_xor_b32 v21, s97, v21
    v_xor_b32 v22, s98, v22
    v_xor_b32 v23, s99, v23
    v_or3_b32 v52, v20, v21, v22
    v_or_b32 v52, v52, v23
    s_waitcnt vmcnt(2)
    v_xor_b32 v24, s96, v24
    v_xor_b32 v25, s97, v25
    v_xor_b32 v26, s98, v26
    v_xor_b32 v27, s99, v27
    v_or3_b32 v52, v24, v25, v52
    v_or3_b32 v52, v26, v27, v52
    s_waitcnt vmcnt(1)
    v_xor_b32 v28, s96, v28
    v_xor_b32 v29, s97, v29
    v_xor_b32 v30, s98, v30
    v_xor_b32 v31, s99, v31
    v_or3_b32 v52, v28, v29, v52
    v_or3_b32 v52, v30, v31, v52
    s_waitcnt vmcnt(0)
    v_xor_b32 v32, s96, v32
    v_xor_b32 v33, s97, v33
    v_xor_b32 v34, s98, v34
    v_xor_b32 v35, s99, v35
    v_or3_b32 v52, v32, v33, v52
    v_or3_b32 v52, v34, v35, v52
    v_cmp_ne_u32_sdwa vcc, v52, 0 src0_sel:BYTE_0 src1_sel:DWORD
    s_cbranch_vccnz L_rt_3
    v_pk_add_f32 v[64:65], v[20:21], v[28:29]
    v_pk_add_f32 v[66:67], v[22:23], v[30:31]
    v_pk_add_f32 v[68:69], v[24:25], v[32:33]
    v_pk_add_f32 v[70:71], v[26:27], v[34:35]
    v_cvt_pk_bf16_f32 v65, v64, v65
    v_cvt_pk_bf16_f32 v67, v66, v67
    v_cvt_pk_bf16_f32 v69, v68, v69
    v_cvt_pk_bf16_f32 v71, v70, v71
    v_lshlrev_b32 v64, 16, v65
    v_and_b32 v65, s37, v65
    v_lshlrev_b32 v66, 16, v67
    v_and_b32 v67, s37, v67
    v_lshlrev_b32 v68, 16, v69
    v_and_b32 v69, s37, v69
    v_lshlrev_b32 v70, 16, v71
    v_and_b32 v71, s37, v71
    ds_write_b128 v18, v[64:67] offset:0
    ds_write_b128 v18, v[68:71] offset:1024
    v_mov_b32 v10, 1
    ds_write_b32 v19, v10
    s_barrier
    ds_read2_b32 v[20:21], v8 offset0:0 offset1:32
    s_branch L_m_join
L_m_ln:
    s_cmp_eq_u32 s3, 0
    s_cselect_b32 s54, 200, 0
    s_waitcnt vmcnt(0)
    s_barrier
    ds_read_b64_tr_b16 v[96:97], v12 offset:0
    ds_read_b64_tr_b16 v[98:99], v12 offset:4096
    ds_read_b64_tr_b16 v[100:101], v12 offset:8
    ds_read_b64_tr_b16 v[102:103], v12 offset:4104
    ds_read_b64_tr_b16 v[104:105], v12 offset:16
    ds_read_b64_tr_b16 v[106:107], v12 offset:4112
    ds_read_b64_tr_b16 v[108:109], v12 offset:24
    ds_read_b64_tr_b16 v[110:111], v12 offset:4120
    v_lshlrev_b32 v16, 16, v16
    s_lshl_b32 s48, s41, 12
    s_lshl_b32 s49, s40, 11
    s_add_u32 s48, s48, s49
    s_add_u32 s48, s48, 1343488
    v_lshl_add_u32 v2, v0, 4, s48
    global_load_dwordx4 v[56:59], v2, s[34:35] nt
    global_load_dwordx4 v[60:63], v2, s[34:35] offset:1024 nt
    s_lshl_b32 s48, s100, 12
    s_add_u32 s48, s48, 409600
    v_lshl_add_u32 v3, v0, 4, s48
L_m_poll0:
    global_load_dwordx4 v[20:23], v3, s[34:35] offset:0 sc1
    global_load_dwordx4 v[24:27], v3, s[34:35] offset:1024 sc1
    global_load_dwordx4 v[28:31], v3, s[34:35] offset:2048 sc1
    global_load_dwordx4 v[32:35], v3, s[34:35] offset:3072 sc1
    s_waitcnt vmcnt(3)
    v_xor_b32 v20, s96, v20
    v_xor_b32 v21, s97, v21
    v_xor_b32 v22, s98, v22
    v_xor_b32 v23, s99, v23
    v_or3_b32 v52, v20, v21, v22
    v_or_b32 v52, v52, v23
    s_waitcnt vmcnt(2)
    v_xor_b32 v24, s96, v24
    v_xor_b32 v25, s97, v25
    v_xor_b32 v26, s98, v26
    v_xor_b32 v27, s99, v27
    v_or3_b32 v52, v24, v25, v52
    v_or3_b32 v52, v26, v27, v52
    s_waitcnt vmcnt(1)
    v_xor_b32 v28, s96, v28
    v_xor_b32 v29, s97, v29
    v_xor_b32 v30, s98, v30
    v_xor_b32 v31, s99, v31
    v_or3_b32 v52, v28, v29, v52
    v_or3_b32 v52, v30, v31, v52
    s_waitcnt vmcnt(0)
    v_xor_b32 v32, s96, v32
    v_xor_b32 v33, s97, v33
    v_xor_b32 v34, s98, v34
    v_xor_b32 v35, s99, v35
    v_or3_b32 v52, v32, v33, v52
    v_or3_b32 v52, v34, v35, v52
    v_cmp_ne_u32_sdwa vcc, v52, 0 src0_sel:BYTE_0 src1_sel:DWORD
    s_cbranch_vccnz L_rt_4
    v_pk_add_f32 v[72:73], v[20:21], v[28:29]
    v_pk_add_f32 v[74:75], v[22:23], v[30:31]
    v_pk_add_f32 v[76:77], v[24:25], v[32:33]
    v_pk_add_f32 v[78:79], v[26:27], v[34:35]
    v_cvt_pk_bf16_f32 v73, v72, v73
    v_cvt_pk_bf16_f32 v75, v74, v75
    v_cvt_pk_bf16_f32 v77, v76, v77
    v_cvt_pk_bf16_f32 v79, v78, v79
    v_lshlrev_b32 v72, 16, v73
    v_and_b32 v73, s37, v73
    v_lshlrev_b32 v74, 16, v75
    v_and_b32 v75, s37, v75
    v_lshlrev_b32 v76, 16, v77
    v_and_b32 v77, s37, v77
    v_lshlrev_b32 v78, 16, v79
    v_and_b32 v79, s37, v79
    global_load_dwordx4 v[56:59], v2, s[34:35] nt
    global_load_dwordx4 v[60:63], v2, s[34:35] offset:1024 nt
    v_pk_add_f32 v[72:73], v[72:73], 1.0 op_sel_hi:[1,0]
    v_pk_add_f32 v[74:75], v[74:75], 1.0 op_sel_hi:[1,0]
    v_pk_add_f32 v[76:77], v[76:77], 1.0 op_sel_hi:[1,0]
    v_pk_add_f32 v[78:79], v[78:79], 1.0 op_sel_hi:[1,0]
    v_cvt_pk_bf16_f32 v73, v72, v73
    v_cvt_pk_bf16_f32 v75, v74, v75
    v_cvt_pk_bf16_f32 v77, v76, v77
    v_cvt_pk_bf16_f32 v79, v78, v79
    v_lshlrev_b32 v72, 16, v73
    v_and_b32 v73, s37, v73
    v_lshlrev_b32 v74, 16, v75
    v_and_b32 v75, s37, v75
    v_lshlrev_b32 v76, 16, v77
    v_and_b32 v77, s37, v77
    v_lshlrev_b32 v78, 16, v79
    v_and_b32 v79, s37, v79
L_m_scs:
    ds_read_b32 v10, v19
    ds_read_b128 v[64:67], v18 offset:0
    ds_read_b128 v[68:71], v18 offset:1024
    s_sub_u32 s39, s39, 1
    s_cbranch_scc1 L_end
    s_waitcnt lgkmcnt(0)
    v_cmp_eq_u32 vcc, 0, v10
    s_cbranch_vccnz L_m_scs
    s_mul_i32 s48, s40, 1088
    s_add_u32 s48, s48, 135168
    v_lshl_add_u32 v3, v0, 3, s48
    s_lshl_b32 s48, s40, 3
    s_add_u32 s48, s48, 134912
    v_mov_b32 v4, s48
    s_branch L_m_chk2
L_m_again:
    s_sub_u32 s54, s54, 1
    s_cbranch_scc0 L_m_poll2
    s_mov_b32 s54, 0
    v_xor_b32 v2, 524288, v2
    s_sub_u32 s39, s39, 1
    s_cbranch_scc1 L_end
L_m_poll2:
    s_mov_b64 exec, s[50:51]
    s_cbranch_execz L_m_sk1
    global_load_dwordx4 v[56:59], v2, s[34:35] nt
L_m_sk1:
    s_mov_b64 exec, s[52:53]
    s_cbranch_execz L_m_sk2
    global_load_dwordx4 v[60:63], v2, s[34:35] offset:1024 nt
L_m_sk2:
    s_mov_b64 exec, -1
L_m_chk2:
    s_waitcnt vmcnt(0)
    v_xor_b32 v28, s96, v56
    v_xor_b32 v29, s97, v57
    v_xor_b32 v30, s98, v58
    v_xor_b32 v31, s99, v59
    v_or3_b32 v52, v28, v29, v30
    v_or_b32 v52, v52, v31
    v_cmp_ne_u32_sdwa s[50:51], v52, 0 src0_sel:BYTE_0 src1_sel:DWORD
    v_xor_b32 v32, s96, v60
    v_xor_b32 v33, s97, v61
    v_xor_b32 v34, s98, v62
    v_xor_b32 v35, s99, v63
    v_or3_b32 v53, v32, v33, v34
    v_or_b32 v53, v53, v35
    v_cmp_ne_u32_sdwa s[52:53], v53, 0 src0_sel:BYTE_0 src1_sel:DWORD
    s_nop 0
    s_or_b64 s[100:101], s[50:51], s[52:53]
    s_cbranch_scc1 L_m_again
L_m_go:
    v_readfirstlane_b32 s14, v28
    s_nop 1
    v_pk_add_f32 v[36:37], v[28:29], s[14:15] op_sel_hi:[1,0] neg_lo:[0,1] neg_hi:[0,1]
    v_pk_add_f32 v[38:39], v[30:31], s[14:15] op_sel_hi:[1,0] neg_lo:[0,1] neg_hi:[0,1]
    v_pk_add_f32 v[40:41], v[32:33], s[14:15] op_sel_hi:[1,0] neg_lo:[0,1] neg_hi:[0,1]
    v_pk_add_f32 v[42:43], v[34:35], s[14:15] op_sel_hi:[1,0] neg_lo:[0,1] neg_hi:[0,1]
    v_pk_add_f32 v[44:45], v[36:37], v[38:39]
    v_pk_mul_f32 v[46:47], v[36:37], v[36:37]
    v_pk_add_f32 v[48:49], v[40:41], v[42:43]
    v_pk_fma_f32 v[46:47], v[38:39], v[38:39], v[46:47]
    v_pk_add_f32 v[44:45], v[44:45], v[48:49]
    v_pk_fma_f32 v[46:47], v[40:41], v[40:41], v[46:47]
    v_add_f32 v44, v44, v45
    v_pk_fma_f32 v[46:47], v[42:43], v[42:43], v[46:47]
    v_add_f32 v46, v46, v47
    v_pk_mul_f32 v[28:29], v[36:37], v[72:73]
    v_add_f32_dpp v44, v44, v44 quad_perm:[1,0,3,2] row_mask:0xf bank_mask:0xf
    v_add_f32_dpp v46, v46, v46 quad_perm:[1,0,3,2] row_mask:0xf bank_mask:0xf
    v_pk_mul_f32 v[30:31], v[38:39], v[74:75]
    v_add_f32_dpp v44, v44, v44 quad_perm:[2,3,0,1] row_mask:0xf bank_mask:0xf
    v_add_f32_dpp v46, v46, v46 quad_perm:[2,3,0,1] row_mask:0xf bank_mask:0xf
    v_pk_mul_f32 v[32:33], v[40:41], v[76:77]
    v_add_f32_dpp v44, v44, v44 row_ror:4 row_mask:0xf bank_mask:0xf
    v_add_f32_dpp v46, v46, v46 row_ror:4 row_mask:0xf bank_mask:0xf
    v_pk_mul_f32 v[34:35], v[42:43], v[78:79]
    v_add_f32_dpp v44, v44, v44 row_ror:8 row_mask:0xf bank_mask:0xf
    v_add_f32_dpp v46, v46, v46 row_ror:8 row_mask:0xf bank_mask:0xf
    s_nop 0
    v_add_f32_dpp v44, v44, v44 row_bcast:15 row_mask:0xa bank_mask:0xf
    v_add_f32_dpp v46, v46, v46 row_bcast:15 row_mask:0xa bank_mask:0xf
    s_nop 0
    v_add_f32_dpp v44, v44, v44 row_bcast:31 row_mask:0xc bank_mask:0xf
    v_add_f32_dpp v46, v46, v46 row_bcast:31 row_mask:0xc bank_mask:0xf
    v_mul_f32 v44, 0x3b000000, v44
    v_mul_f32 v46, 0x3b000000, v46
    v_fma_f32 v46, -v44, v44, v46
    v_max_f32 v46, 0, v46
    v_add_f32 v46, 0x3727c5ac, v46
    v_readlane_b32 s14, v44, 63
    v_rsq_f32 v46, v46
    s_nop 0
    v_pk_fma_f32 v[28:29], v[72:73], s[14:15], v[28:29] op_sel_hi:[1,0,1] neg_lo:[0,1,0] neg_hi:[0,1,0]
    v_pk_fma_f32 v[30:31], v[74:75], s[14:15], v[30:31] op_sel_hi:[1,0,1] neg_lo:[0,1,0] neg_hi:[0,1,0]
    v_readlane_b32 s50, v46, 63
    v_pk_fma_f32 v[32:33], v[76:77], s[14:15], v[32:33] op_sel_hi:[1,0,1] neg_lo:[0,1,0] neg_hi:[0,1,0]
    v_pk_fma_f32 v[34:35], v[78:79], s[14:15], v[34:35] op_sel_hi:[1,0,1] neg_lo:[0,1,0] neg_hi:[0,1,0]
    v_pk_fma_f32 v[28:29], v[28:29], s[50:51], v[64:65] op_sel_hi:[1,0,1]
    v_pk_fma_f32 v[30:31], v[30:31], s[50:51], v[66:67] op_sel_hi:[1,0,1]
    v_pk_fma_f32 v[32:33], v[32:33], s[50:51], v[68:69] op_sel_hi:[1,0,1]
    v_pk_fma_f32 v[34:35], v[34:35], s[50:51], v[70:71] op_sel_hi:[1,0,1]
    v_cvt_pk_bf16_f32 v22, v28, v29
    v_cvt_pk_bf16_f32 v23, v30, v31
    ds_write_b64 v3, v[22:23]
    v_cvt_pk_bf16_f32 v24, v32, v33
    v_cvt_pk_bf16_f32 v25, v34, v35
    ds_write_b64 v3, v[24:25] offset:512
    v_readfirstlane_b32 s14, v28
    s_nop 1
    v_pk_add_f32 v[36:37], v[28:29], s[14:15] op_sel_hi:[1,0] neg_lo:[0,1] neg_hi:[0,1]
    v_pk_add_f32 v[38:39], v[30:31], s[14:15] op_sel_hi:[1,0] neg_lo:[0,1] neg_hi:[0,1]
    v_pk_add_f32 v[40:41], v[32:33], s[14:15] op_sel_hi:[1,0] neg_lo:[0,1] neg_hi:[0,1]
    v_pk_add_f32 v[42:43], v[34:35], s[14:15] op_sel_hi:[1,0] neg_lo:[0,1] neg_hi:[0,1]
    v_pk_add_f32 v[44:45], v[36:37], v[38:39]
    v_pk_mul_f32 v[46:47], v[36:37], v[36:37]
    v_pk_add_f32 v[48:49], v[40:41], v[42:43]
    v_pk_fma_f32 v[46:47], v[38:39], v[38:39], v[46:47]
    v_pk_add_f32 v[44:45], v[44:45], v[48:49]
    v_pk_fma_f32 v[46:47], v[40:41], v[40:41], v[46:47]
    v_add_f32 v44, v44, v45
    v_pk_fma_f32 v[46:47], v[42:43], v[42:43], v[46:47]
    v_add_f32 v46, v46, v47
    s_waitcnt lgkmcnt(0)
    s_barrier
    ds_read2_b32 v[20:21], v8 offset0:0 offset1:32
    v_add_f32_dpp v44, v44, v44 quad_perm:[1,0,3,2] row_mask:0xf bank_mask:0xf
    v_add_f32_dpp v46, v46, v46 quad_perm:[1,0,3,2] row_mask:0xf bank_mask:0xf
    s_nop 0
    v_add_f32_dpp v44, v44, v44 quad_perm:[2,3,0,1] row_mask:0xf bank_mask:0xf
    v_add_f32_dpp v46, v46, v46 quad_perm:[2,3,0,1] row_mask:0xf bank_mask:0xf
    s_nop 0
    v_add_f32_dpp v44, v44, v44 row_ror:4 row_mask:0xf bank_mask:0xf
    v_add_f32_dpp v46, v46, v46 row_ror:4 row_mask:0xf bank_mask:0xf
    s_nop 0
    v_add_f32_dpp v44, v44, v44 row_ror:8 row_mask:0xf bank_mask:0xf
    v_add_f32_dpp v46, v46, v46 row_ror:8 row_mask:0xf bank_mask:0xf
    s_nop 0
    v_add_f32_dpp v44, v44, v44 row_bcast:15 row_mask:0xa bank_mask:0xf
    v_add_f32_dpp v46, v46, v46 row_bcast:15 row_mask:0xa bank_mask:0xf
    s_nop 0
    v_add_f32_dpp v44, v44, v44 row_bcast:31 row_mask:0xc bank_mask:0xf
    v_add_f32_dpp v46, v46, v46 row_bcast:31 row_mask:0xc bank_mask:0xf
    v_mul_f32 v44, 0x3b000000, v44
    v_mul_f32 v46, 0x3b000000, v46
    v_fma_f32 v46, -v44, v44, v46
    v_max_f32 v46, 0, v46
    v_add_f32 v44, s14, v44
    v_add_f32 v46, 0x3727c5ac, v46
    v_rsq_f32 v45, v46
    s_mov_b32 exec_lo, 0
    s_mov_b32 exec_hi, 0x80000000
    ds_write_b64 v4, v[44:45]
    s_mov_b64 exec, -1
L_m_join:
    s_waitcnt lgkmcnt(0)
    s_barrier
    ds_read2st64_b32 v[28:29], v7 offset0:0 offset1:1
    ds_read_b64 v[30:31], v9
    v_add_f32 v20, v20, v21
    s_waitcnt lgkmcnt(0)
    v_add_f32 v28, v28, v29
    v_fma_f32 v28, -v30, v20, v28
    v_fma_f32 v28, v28, v31, v16
    v_mul_f32 v29, v28, v28
    v_fmac_f32 v114, 0xbdd2d3e8, v29
    v_mul_f32 v29, v114, v28
    v_exp_f32 v29, v29
    s_nop 0
    v_add_f32 v29, 1.0, v29
    v_rcp_f32 v29, v29
    s_nop 0
    v_mul_f32 v28, v28, v29
    s_nop 1
    v_mov_b32_dpp v29, v28 row_shl:1 row_mask:0xf bank_mask:0xf
    v_cvt_pk_bf16_f32 v30, v28, v29
    s_nop 1
    v_mov_b32_dpp v31, v30 row_shl:4 row_mask:0xf bank_mask:0xf
    v_mov_b32_dpp v32, v30 quad_perm:[0,0,0,0] row_mask:0xf bank_mask:0xf
    v_mov_b32_dpp v33, v30 quad_perm:[2,2,2,2] row_mask:0xf bank_mask:0xf
    v_mov_b32_dpp v34, v31 quad_perm:[0,0,0,0] row_mask:0xf bank_mask:0xf
    v_mov_b32_dpp v35, v31 quad_perm:[2,2,2,2] row_mask:0xf bank_mask:0xf
    s_nop 1
    v_mfma_f32_16x16x32_bf16 v[36:39], v[96:99], v[32:35], 0
    v_mfma_f32_16x16x32_bf16 v[40:43], v[100:103], v[32:35], 0
    v_mfma_f32_16x16x32_bf16 v[44:47], v[104:107], v[32:35], 0
    v_mfma_f32_16x16x32_bf16 v[48:51], v[108:111], v[32:35], 0
    s_mov_b32 exec_lo, 0x0f0f0f0f
    s_mov_b32 exec_hi, 0x0f0f0f0f
    s_nop 3
    v_cndmask_b32 v36, v36, v40, s[86:87]
    v_cndmask_b32 v37, v37, v41, s[86:87]
    v_cndmask_b32 v38, v38, v42, s[86:87]
    v_cndmask_b32 v39, v39, v43, s[86:87]
    v_cndmask_b32 v36, v36, v44, s[88:89]
    v_cndmask_b32 v37, v37, v45, s[88:89]
    v_cndmask_b32 v38, v38, v46, s[88:89]
    v_cndmask_b32 v39, v39, v47, s[88:89]
    v_cndmask_b32 v36, v36, v48, s[90:91]
    v_cndmask_b32 v37, v37, v49, s[90:91]
    v_cndmask_b32 v38, v38, v50, s[90:91]
    v_cndmask_b32 v39, v39, v51, s[90:91]
    v_mov_b32_sdwa v36, s32 dst_sel:BYTE_0 dst_unused:UNUSED_PRESERVE src0_sel:BYTE_0
    v_mov_b32_sdwa v37, s32 dst_sel:BYTE_0 dst_unused:UNUSED_PRESERVE src0_sel:BYTE_1
    v_mov_b32_sdwa v38, s32 dst_sel:BYTE_0 dst_unused:UNUSED_PRESERVE src0_sel:BYTE_2
    v_mov_b32_sdwa v39, s32 dst_sel:BYTE_0 dst_unused:UNUSED_PRESERVE src0_sel:BYTE_3
    global_store_dwordx4 v5, v[36:39], s[34:35] sc1
    s_branch L_end
L_roleR:
    s_sub_u32 s46, s42, 7
    s_add_u32 m0, s55, 49152
    s_nop 0
    global_load_lds_dwordx4 v26, s[92:93] nt
    v_add_u32 v26, s94, v26
    s_add_u32 m0, s55, 57344
    s_nop 0
    global_load_lds_dwordx4 v26, s[92:93] nt
    v_add_u32 v26, s94, v26
    s_add_u32 m0, s55, 65536
    s_nop 0
    global_load_lds_dwordx4 v26, s[92:93] nt
    v_add_u32 v26, s94, v26
    s_add_u32 m0, s55, 73728
    s_nop 0
    global_load_lds_dwordx4 v26, s[92:93] nt
    v_add_u32 v26, s94, v26
    s_waitcnt vmcnt(1)
    s_barrier
    s_add_u32 m0, s55, 81920
    s_nop 0
    global_load_lds_dwordx4 v26, s[92:93] nt
    v_add_u32 v26, s94, v26
    s_add_u32 m0, s55, 90112
    s_nop 0
    global_load_lds_dwordx4 v26, s[92:93] nt
    v_add_u32 v26, s94, v26
    s_add_u32 m0, s55, 98304
    s_nop 0
    global_load_lds_dwordx4 v26, s[92:93] nt
    v_add_u32 v26, s94, v26
    s_cmp_lt_u32 s40, 4
    s_cbranch_scc1 L_r_nm
    s_lshl_b32 s48, s41, 7
    s_lshl_b32 s49, s46, 4
    s_add_u32 s48, s48, s49
    s_lshl_b32 s49, s40, 2
    s_add_u32 s48, s48, s49
    s_add_u32 s48, s48, 1318896
    v_mov_b32 v14, s48
    s_mov_b64 exec, 1
    global_store_dword v14, v6, s[34:35]
    s_mov_b64 exec, -1
L_r_nm:
    s_add_u32 m0, s55, 106496
    s_nop 0
    global_load_lds_dwordx4 v26, s[92:93] nt
    v_add_u32 v26, s94, v26
    v_lshrrev_b32 v8, 4, v0
    s_and_b32 s52, s46, 1
    s_lshr_b32 s53, s46, 1
    s_and_b32 s54, s40, 1
    s_lshr_b32 s100, s40, 1
    s_lshl_b32 s101, s41, 3
    s_lshl_b32 s49, s52, 2
    s_add_u32 s101, s101, s49
    s_add_u32 s101, s101, s100
    s_lshl_b32 s48, s101, 12
    s_lshl_b32 s49, s54, 8
    s_add_u32 s48, s48, s49
    s_add_u32 s48, s48, 1048576
    v_and_b32 v11, 15, v0
    v_lshlrev_b32 v2, 9, v8
    v_lshlrev_b32 v3, 4, v11
    v_add3_u32 v2, v2, v3, s48
    s_lshl_b32 s48, s101, 7
    s_add_u32 s48, s48, 1310720
    v_and_b32 v3, 7, v0
    v_xor_b32 v3, v3, v8
    v_lshl_add_u32 v3, v3, 4, s48
    s_and_b32 s100, s100, 1
    s_mul_i32 s48, s100, 576
    s_lshl_b32 s49, s50, 8
    s_add_u32 s48, s48, s49
    s_lshl_b32 s49, s54, 7
    s_add_u32 s48, s48, s49
    s_add_u32 s48, s48, 132096
    v_lshlrev_b32 v19, 15, v11
    v_lshl_add_u32 v11, v11, 2, v8
    v_lshl_add_u32 v11, v11, 1, s48
    v_lshrrev_b32 v12, 4, v0
    v_bfe_u32 v22, v0, 2, 2
    v_lshl_add_u32 v12, v12, 3, v22
    v_mul_u32_u24 v12, 256, v12
    v_bfe_u32 v23, v0, 4, 1
    v_lshl_add_u32 v23, v23, 2, v22
    v_xor_b32 v23, s40, v23
    v_lshl_add_u32 v12, v23, 5, v12
    v_and_b32 v22, 3, v0
    v_lshl_add_u32 v12, v22, 3, v12
    v_add_u32 v12, 49152, v12
    s_mov_b32 s48, 132096
    v_and_b32 v13, 1, v0
    v_mul_u32_u24 v13, 576, v13
    v_and_b32 v22, 48, v0
    v_add3_u32 v13, v13, v22, s48
    s_lshl_b32 s48, s53, 13
    s_lshl_b32 s49, s40, 10
    s_add_u32 s48, s48, s49
    s_lshl_b32 s49, s41, 7
    s_add_u32 s48, s48, s49
    s_lshl_b32 s49, s52, 6
    s_add_u32 s48, s48, s49
    s_add_u32 s48, s48, 786432
    v_add3_u32 v19, v19, v22, s48
    s_mov_b64 s[84:85], -1
    s_mov_b64 s[86:87], -1
    s_cmp_eq_u32 s3, 0
    s_cselect_b32 s54, 200, 0
    v_mov_b32 v26, s32
    s_mov_b32 s53, -1
    s_waitcnt vmcnt(0)
    s_mov_b32 exec_lo, 0x00ff00ff
    s_mov_b32 exec_hi, 0x00ff00ff
    global_load_dwordx4 v[24:27], v3, s[34:35] nt
    s_mov_b64 exec, -1
    global_load_dwordx4 v[64:67], v2, s[34:35] offset:0 nt
    global_load_dwordx4 v[68:71], v2, s[34:35] offset:2048 nt
    s_barrier
    ds_read_b64_tr_b16 v[96:97], v12 offset:0
    ds_read_b64_tr_b16 v[98:99], v12 offset:1024
    ds_read_b64_tr_b16 v[100:101], v12 offset:8192
    ds_read_b64_tr_b16 v[102:103], v12 offset:9216
    ds_read_b64_tr_b16 v[104:105], v12 offset:16384
    ds_read_b64_tr_b16 v[106:107], v12 offset:17408
    ds_read_b64_tr_b16 v[108:109], v12 offset:24576
    ds_read_b64_tr_b16 v[110:111], v12 offset:25600
    ds_read_b64_tr_b16 v[112:113], v12 offset:32768
    ds_read_b64_tr_b16 v[114:115], v12 offset:33792
    ds_read_b64_tr_b16 v[116:117], v12 offset:40960
    ds_read_b64_tr_b16 v[118:119], v12 offset:41984
    ds_read_b64_tr_b16 v[120:121], v12 offset:49152
    ds_read_b64_tr_b16 v[122:123], v12 offset:50176
    ds_read_b64_tr_b16 v[124:125], v12 offset:57344
    ds_read_b64_tr_b16 v[126:127], v12 offset:58368
    s_waitcnt vmcnt(2)
    v_cmp_ne_u32 vcc, s32, v26
    s_cbranch_vccz L_a_st1
    s_waitcnt vmcnt(0)
    v_xor_b32 v80, s96, v64
    v_xor_b32 v81, s97, v65
    v_xor_b32 v82, s98, v66
    v_xor_b32 v83, s99, v67
    v_or3_b32 v32, v80, v81, v82
    v_or_b32 v32, v32, v83
    v_xor_b32 v84, s96, v68
    v_xor_b32 v85, s97, v69
    v_xor_b32 v86, s98, v70
    v_xor_b32 v87, s99, v71
    v_or3_b32 v33, v84, v85, v86
    v_or_b32 v33, v33, v87
    v_cmp_ne_u32_sdwa s[84:85], v32, 0 src0_sel:BYTE_0 src1_sel:DWORD
    v_cmp_ne_u32_sdwa s[86:87], v33, 0 src0_sel:BYTE_0 src1_sel:DWORD
L_a_poll1:
    s_mov_b64 exec, vcc
    global_load_dwordx4 v[24:27], v3, s[34:35] nt
    s_mov_b64 exec, -1
    s_waitcnt vmcnt(0)
    v_cmp_ne_u32 vcc, s32, v26
    s_cbranch_vccz L_a_st
    s_sub_u32 s54, s54, 1
    s_cbranch_scc1 L_a_slow1
    s_bcnt1_i32_b32 s48, vcc_lo
    s_and_b32 s48, s48, s53
    s_sub_u32 s48, s48, 1
    s_cmp_ge_u32 s48, 4
    s_cbranch_scc1 L_a_poll1
    s_mov_b32 s53, 0
    s_mov_b64 exec, s[84:85]
    s_cbranch_execz L_sk_5
    global_load_dwordx4 v[64:67], v2, s[34:35] offset:0 nt
L_sk_5:
    s_mov_b64 exec, s[86:87]
    s_cbranch_execz L_sk_6
    global_load_dwordx4 v[68:71], v2, s[34:35] offset:2048 nt
L_sk_6:
    s_mov_b64 exec, -1
    s_waitcnt vmcnt(0)
    v_xor_b32 v80, s96, v64
    v_xor_b32 v81, s97, v65
    v_xor_b32 v82, s98, v66
    v_xor_b32 v83, s99, v67
    v_or3_b32 v32, v80, v81, v82
    v_or_b32 v32, v32, v83
    v_xor_b32 v84, s96, v68
    v_xor_b32 v85, s97, v69
    v_xor_b32 v86, s98, v70
    v_xor_b32 v87, s99, v71
    v_or3_b32 v33, v84, v85, v86
    v_or_b32 v33, v33, v87
    v_cmp_ne_u32_sdwa s[84:85], v32, 0 src0_sel:BYTE_0 src1_sel:DWORD
    v_cmp_ne_u32_sdwa s[86:87], v33, 0 src0_sel:BYTE_0 src1_sel:DWORD
    s_branch L_a_poll1
L_a_slow1:
    s_mov_b32 s54, 0
    v_xor_b32 v3, 524288, v3
    s_sub_u32 s39, s39, 1
    s_cbranch_scc0 L_a_poll1
    s_branch L_end
L_a_st:
    s_mov_b64 exec, s[84:85]
    s_cbranch_execz L_sk_7
    global_load_dwordx4 v[64:67], v2, s[34:35] offset:0 nt
L_sk_7:
    s_mov_b64 exec, s[86:87]
    s_cbranch_execz L_sk_8
    global_load_dwordx4 v[68:71], v2, s[34:35] offset:2048 nt
L_sk_8:
    s_mov_b64 exec, -1
L_a_st1:
    v_max_f32_dpp v36, v24, v24 quad_perm:[1,0,3,2] row_mask:0xf bank_mask:0xf
    s_nop 1
    v_max_f32_dpp v36, v36, v36 quad_perm:[2,3,0,1] row_mask:0xf bank_mask:0xf
    s_nop 1
    v_max_f32_dpp v36, v36, v36 row_half_mirror row_mask:0xf bank_mask:0xf
    v_sub_f32 v38, v24, v36
    v_mul_f32 v38, 0x3fb8aa3b, v38
    v_exp_f32 v38, v38
    s_nop 0
    v_mul_f32 v39, v38, v25
    s_nop 1
    v_add_f32_dpp v39, v39, v39 quad_perm:[1,0,3,2] row_mask:0xf bank_mask:0xf
    s_nop 1
    v_add_f32_dpp v39, v39, v39 quad_perm:[2,3,0,1] row_mask:0xf bank_mask:0xf
    s_nop 1
    v_add_f32_dpp v39, v39, v39 row_half_mirror row_mask:0xf bank_mask:0xf
    v_rcp_f32 v39, v39
    s_nop 0
    v_mul_f32 v38, v38, v39
    s_branch L_a_chk2
L_a_again:
    s_sub_u32 s54, s54, 1
    s_cbranch_scc0 L_a_poll2
    s_mov_b32 s54, 0
    v_xor_b32 v2, 524288, v2
    s_sub_u32 s39, s39, 1
    s_cbranch_scc1 L_end
L_a_poll2:
    s_mov_b64 exec, s[84:85]
    s_cbranch_execz L_sk_9
    global_load_dwordx4 v[64:67], v2, s[34:35] offset:0 nt
L_sk_9:
    s_mov_b64 exec, s[86:87]
    s_cbranch_execz L_sk_10
    global_load_dwordx4 v[68:71], v2, s[34:35] offset:2048 nt
L_sk_10:
    s_mov_b64 exec, -1
L_a_chk2:
    s_waitcnt vmcnt(0)
    v_xor_b32 v80, s96, v64
    v_xor_b32 v81, s97, v65
    v_xor_b32 v82, s98, v66
    v_xor_b32 v83, s99, v67
    v_or3_b32 v32, v80, v81, v82
    v_or_b32 v32, v32, v83
    v_xor_b32 v84, s96, v68
    v_xor_b32 v85, s97, v69
    v_xor_b32 v86, s98, v70
    v_xor_b32 v87, s99, v71
    v_or3_b32 v33, v84, v85, v86
    v_or_b32 v33, v33, v87
    v_cmp_ne_u32_sdwa s[84:85], v32, 0 src0_sel:BYTE_0 src1_sel:DWORD
    v_cmp_ne_u32_sdwa s[86:87], v33, 0 src0_sel:BYTE_0 src1_sel:DWORD
    v_mul_f32_dpp v28, v38, v80 row_newbcast:0 row_mask:0xf bank_mask:0xf
    v_mul_f32_dpp v29, v38, v81 row_newbcast:0 row_mask:0xf bank_mask:0xf
    v_mul_f32_dpp v30, v38, v82 row_newbcast:0 row_mask:0xf bank_mask:0xf
    v_mul_f32_dpp v31, v38, v83 row_newbcast:0 row_mask:0xf bank_mask:0xf
    s_or_b64 s[100:101], s[84:85], s[86:87]
    s_cbranch_scc1 L_a_again
L_a_go:
    v_fmac_f32_dpp v28, v38, v84 row_newbcast:4 row_mask:0xf bank_mask:0xf
    v_fmac_f32_dpp v29, v38, v85 row_newbcast:4 row_mask:0xf bank_mask:0xf
    v_fmac_f32_dpp v30, v38, v86 row_newbcast:4 row_mask:0xf bank_mask:0xf
    v_fmac_f32_dpp v31, v38, v87 row_newbcast:4 row_mask:0xf bank_mask:0xf
    s_nop 0
    v_permlane32_swap_b32 v28, v30
    v_permlane32_swap_b32 v29, v31
    v_add_f32 v28, v28, v30
    v_add_f32 v29, v29, v31
    s_nop 1
    v_permlane16_swap_b32 v28, v29
    v_add_f32 v28, v28, v29
    v_cvt_pk_bf16_f32 v28, v28, v28
    ds_write_b16 v11, v28
    s_waitcnt lgkmcnt(0)
    s_barrier
    ds_read_b128 v[32:35], v13 offset:0
    ds_read_b128 v[36:39], v13 offset:64
    ds_read_b128 v[40:43], v13 offset:128
    ds_read_b128 v[44:47], v13 offset:192
    ds_read_b128 v[48:51], v13 offset:256
    ds_read_b128 v[52:55], v13 offset:320
    ds_read_b128 v[56:59], v13 offset:384
    ds_read_b128 v[60:63], v13 offset:448
    s_waitcnt lgkmcnt(7)
    v_mfma_f32_16x16x32_bf16 v[28:31], v[96:99], v[32:35], 0
    s_waitcnt lgkmcnt(6)
    v_mfma_f32_16x16x32_bf16 v[28:31], v[100:103], v[36:39], v[28:31]
    s_waitcnt lgkmcnt(5)
    v_mfma_f32_16x16x32_bf16 v[28:31], v[104:107], v[40:43], v[28:31]
    s_waitcnt lgkmcnt(4)
    v_mfma_f32_16x16x32_bf16 v[28:31], v[108:111], v[44:47], v[28:31]
    s_waitcnt lgkmcnt(3)
    v_mfma_f32_16x16x32_bf16 v[28:31], v[112:115], v[48:51], v[28:31]
    s_waitcnt lgkmcnt(2)
    v_mfma_f32_16x16x32_bf16 v[28:31], v[116:119], v[52:55], v[28:31]
    s_waitcnt lgkmcnt(1)
    v_mfma_f32_16x16x32_bf16 v[28:31], v[120:123], v[56:59], v[28:31]
    s_waitcnt lgkmcnt(0)
    v_mfma_f32_16x16x32_bf16 v[28:31], v[124:127], v[60:63], v[28:31]
    s_mov_b32 exec_lo, 0x30003
    s_mov_b32 exec_hi, 0x30003
    s_nop 5
    v_mov_b32_sdwa v28, s32 dst_sel:BYTE_0 dst_unused:UNUSED_PRESERVE src0_sel:BYTE_0
    v_mov_b32_sdwa v29, s32 dst_sel:BYTE_0 dst_unused:UNUSED_PRESERVE src0_sel:BYTE_1
    v_mov_b32_sdwa v30, s32 dst_sel:BYTE_0 dst_unused:UNUSED_PRESERVE src0_sel:BYTE_2
    v_mov_b32_sdwa v31, s32 dst_sel:BYTE_0 dst_unused:UNUSED_PRESERVE src0_sel:BYTE_3
    global_store_dwordx4 v19, v[28:31], s[34:35] sc1
    s_mov_b64 exec, -1
    s_branch L_end
L_red:
    s_lshl_b32 s51, s40, 3
    s_add_u32 s51, s51, s46
    v_and_b32 v1, 3, v0
    v_lshrrev_b32 v8, 4, v0
    v_lshl_add_u32 v1, v1, 2, v8
    s_lshl_b32 s48, s51, 5
    v_lshl_add_u32 v18, v1, 1, s48
    global_load_ushort v20, v18, s[4:5]
    v_and_b32 v19, 0x3ff, v18
    global_load_ushort v21, v19, s[24:25]
    v_lshlrev_b32 v9, 3, v8
    v_mov_b32 v10, s32
    v_bfe_u32 v9, v10, v9, 8
    s_load_dword s53, s[34:35], 256
L_nc_11:
    s_waitcnt lgkmcnt(0)
    s_sub_u32 s53, s53, s32
    s_cmp_gt_u32 s53, 1
    s_cbranch_scc1 L_nc_11_r
    s_lshr_b32 s43, s41, 2
    s_xor_b32 s43, s43, s53
    s_lshl_b32 s48, s51, 10
    s_add_u32 s48, s48, 786432
    v_lshl_add_u32 v6, v0, 4, s48
    s_bfe_u32 s47, s51, 0x40001
    s_lshr_b32 s50, s51, 5
    s_xor_b32 s50, s50, s53
    s_and_b32 s52, s51, 1
    s_lshl_b32 s48, s47, 14
    s_lshl_b32 s49, s50, 13
    s_add_u32 s48, s48, s49
    s_lshl_b32 s49, s52, 12
    s_add_u32 s48, s48, s49
    s_add_u32 s48, s48, 524288
    v_lshl_add_u32 v7, v0, 4, s48
    s_lshl_b32 s48, s41, 12
    s_lshl_b32 s49, s51, 6
    s_add_u32 s48, s48, s49
    s_add_u32 s48, s48, 1343488
    v_lshl_add_u32 v14, v1, 2, s48
    v_xor_b32 v15, 524288, v14
    s_lshr_b32 s100, s51, 5
    s_and_b32 s101, s51, 31
    s_lshl_b32 s48, s100, 12
    s_lshl_b32 s49, s101, 6
    s_add_u32 s48, s48, s49
    s_add_u32 s48, s48, 393216
    v_lshl_add_u32 v4, v1, 2, s48
    v_bfe_u32 v5, v0, 2, 1
    v_lshl_add_u32 v4, v5, 11, v4
    v_bfe_u32 v5, v0, 3, 1
    v_mul_u32_u24 v5, 24576, v5
    v_add_u32 v4, v4, v5
    s_and_b32 s50, s41, 3
    s_lshl_b32 s47, s43, 13
    s_lshl_b32 s49, s50, 10
    s_add_u32 s47, s47, s49
    s_lshl_b32 s49, s46, 7
    s_add_u32 s47, s47, s49
    s_add_u32 s47, s47, 32768
    s_waitcnt vmcnt(0) lgkmcnt(0)
    v_lshlrev_b32 v20, 16, v20
    v_lshlrev_b32 v21, 16, v21
    s_cmp_lg_u32 s40, 7
    s_cbranch_scc1 L_r_nf0
    s_not_b32 s80, s32
    s_not_b32 s84, s32
L_r_f0:
    s_sub_u32 s39, s39, 1
    s_cbranch_scc1 L_end
    s_load_dwordx8 s[80:87], s[34:35], s47 glc
    s_sleep 3
    s_xor_b64 s[88:89], s[80:81], s[32:33]
    s_xor_b64 s[90:91], s[82:83], s[32:33]
    s_or_b64 s[88:89], s[88:89], s[90:91]
    s_cbranch_scc0 L_r_nf0
    s_xor_b64 s[88:89], s[84:85], s[32:33]
    s_xor_b64 s[90:91], s[86:87], s[32:33]
    s_or_b64 s[88:89], s[88:89], s[90:91]
    s_cbranch_scc1 L_r_f0
L_r_nf0:
    s_barrier
    global_load_dword v130, v4, s[34:35] sc1
    s_cmp_lg_u32 s40, 7
    s_cbranch_scc1 L_r_nofb
    s_branch L_r_f2
L_r_f1:
    s_sub_u32 s39, s39, 1
    s_cbranch_scc1 L_end
    s_load_dwordx8 s[80:87], s[34:35], s47 glc
    s_sleep 2
L_r_f2:
    s_cmp_eq_u64 s[80:81], s[32:33]
    s_cbranch_scc0 L_r_f1
    s_cmp_eq_u64 s[82:83], s[32:33]
    s_cbranch_scc0 L_r_f1
    s_cmp_eq_u64 s[84:85], s[32:33]
    s_cbranch_scc0 L_r_f1
    s_cmp_eq_u64 s[86:87], s[32:33]
    s_cbranch_scc0 L_r_f1
    s_sleep 10
L_r_nofb:
    s_barrier
    global_load_dwordx4 v[40:43], v6, s[34:35] sc1
    s_waitcnt vmcnt(1)
    s_branch L_r_chk1
L_r_poll1:
    global_load_dword v130, v4, s[34:35] sc1
    s_waitcnt vmcnt(0)
L_r_chk1:
    v_xor_b32 v130, v9, v130
    v_cmp_ne_u32_sdwa vcc, v130, 0 src0_sel:BYTE_0 src1_sel:DWORD
    s_cbranch_vccnz L_rt_12
    v_add_f32_dpp v130, v130, v130 row_shl:4 row_mask:0xf bank_mask:0xf
    v_cvt_pk_bf16_f32 v130, v130, v130
    v_and_b32 v130, s37, v130
    s_mov_b32 s88, 0x000f000f
    s_mov_b32 s89, 0x000f000f
    v_mov_b32_dpp v23, v130 row_shl:8 row_mask:0xf bank_mask:0xf
    s_branch L_r_chk2
L_r_poll2:
    global_load_dwordx4 v[40:43], v6, s[34:35] sc1
L_r_chk2:
    s_waitcnt vmcnt(0)
    v_xor_b32 v40, s96, v40
    v_xor_b32 v41, s97, v41
    v_xor_b32 v42, s98, v42
    v_xor_b32 v43, s99, v43
    v_or3_b32 v52, v40, v41, v42
    v_or_b32 v52, v52, v43
    v_permlane32_swap_b32 v40, v42
    v_permlane32_swap_b32 v41, v43
    v_pk_add_f32 v[40:41], v[40:41], v[42:43]
    v_cmp_ne_u32_sdwa vcc, v52, 0 src0_sel:BYTE_0 src1_sel:DWORD
    s_cbranch_vccnz L_rt_13
    v_permlane16_swap_b32 v40, v41
    v_add_f32 v40, v40, v41
    s_nop 1
    v_add_f32_dpp v40, v40, v40 row_ror:4 row_mask:0xf bank_mask:0xf
    s_nop 1
    v_add_f32_dpp v40, v40, v40 row_ror:8 row_mask:0xf bank_mask:0xf
    v_fmac_f32 v20, v40, v130
    s_mov_b64 exec, s[88:89]
    v_cvt_pk_bf16_f32 v20, v20, v20
    v_and_or_b32 v40, v20, s37, v9
    global_store_dword v14, v40, s[34:35]
    s_cmp_eq_u32 s3, 0
    s_cbranch_scc1 L_r_ns
    global_store_dword v15, v40, s[34:35] sc1
L_r_ns:
    s_mov_b64 exec, -1
    s_cmp_lg_u32 s40, s41
    s_cbranch_scc1 L_end
    s_cmp_lg_u32 s51, 0
    s_cbranch_scc1 L_r_noep
    s_mov_b64 exec, 1
    v_mov_b32 v3, 0
    global_store_dword v3, v10, s[34:35] sc1
    s_mov_b64 exec, -1
L_r_noep:
    v_and_b32 v20, s37, v20
    v_fmac_f32 v20, v21, v23
    s_add_u32 s47, s47, 4096
    v_mov_b32 v72, s96
    v_mov_b32 v73, s97
    v_mov_b32 v74, s98
    v_mov_b32 v75, s99
    s_waitcnt lgkmcnt(0)
    s_not_b32 s80, s32
L_fw_14:
    s_sub_u32 s39, s39, 1
    s_cbranch_scc1 L_end
    s_load_dwordx8 s[80:87], s[34:35], s47 glc
    s_sleep 2
    s_cmp_eq_u64 s[80:81], s[32:33]
    s_cbranch_scc0 L_fw_14
    s_cmp_eq_u64 s[82:83], s[32:33]
    s_cbranch_scc0 L_fw_14
    s_cmp_eq_u64 s[84:85], s[32:33]
    s_cbranch_scc0 L_fw_14
    s_cmp_eq_u64 s[86:87], s[32:33]
    s_cbranch_scc0 L_fw_14
L_r_poll3:
    global_load_dwordx4 v[60:63], v7, s[34:35] offset:0 sc1
    global_load_dwordx4 v[64:67], v7, s[34:35] offset:1024 sc1
    global_load_dwordx4 v[68:71], v7, s[34:35] offset:2048 sc1
    s_mov_b32 exec_hi, 0
    global_load_dwordx4 v[72:75], v7, s[34:35] offset:3072 sc1
    s_mov_b64 exec, -1
    s_waitcnt vmcnt(3)
    v_xor_b32 v60, s96, v60
    v_xor_b32 v61, s97, v61
    v_xor_b32 v62, s98, v62
    v_xor_b32 v63, s99, v63
    v_or3_b32 v52, v60, v61, v62
    v_or_b32 v52, v52, v63
    s_waitcnt vmcnt(2)
    v_xor_b32 v64, s96, v64
    v_xor_b32 v65, s97, v65
    v_xor_b32 v66, s98, v66
    v_xor_b32 v67, s99, v67
    v_or3_b32 v52, v64, v65, v52
    v_or3_b32 v52, v66, v67, v52
    v_pk_add_f32 v[60:61], v[60:61], v[64:65]
    v_pk_add_f32 v[62:63], v[62:63], v[66:67]
    s_waitcnt vmcnt(1)
    v_xor_b32 v68, s96, v68
    v_xor_b32 v69, s97, v69
    v_xor_b32 v70, s98, v70
    v_xor_b32 v71, s99, v71
    v_or3_b32 v52, v68, v69, v52
    v_or3_b32 v52, v70, v71, v52
    v_pk_add_f32 v[60:61], v[60:61], v[68:69]
    v_pk_add_f32 v[62:63], v[62:63], v[70:71]
    s_waitcnt vmcnt(0)
    v_xor_b32 v76, s96, v72
    v_xor_b32 v77, s97, v73
    v_xor_b32 v78, s98, v74
    v_xor_b32 v79, s99, v75
    v_or3_b32 v52, v76, v77, v52
    v_or3_b32 v52, v78, v79, v52
    v_pk_add_f32 v[60:61], v[60:61], v[76:77]
    v_pk_add_f32 v[62:63], v[62:63], v[78:79]
    s_nop 0
    s_nop 0
    v_permlane32_swap_b32 v60, v62
    v_permlane32_swap_b32 v61, v63
    v_pk_add_f32 v[60:61], v[60:61], v[62:63]
    v_cmp_ne_u32_sdwa vcc, v52, 0 src0_sel:BYTE_0 src1_sel:DWORD
    s_cbranch_vccnz L_rt_15
    v_permlane16_swap_b32 v60, v61
    v_add_f32 v60, v60, v61
    s_nop 1
    v_add_f32_dpp v60, v60, v60 row_ror:4 row_mask:0xf bank_mask:0xf
    s_nop 1
    v_add_f32_dpp v60, v60, v60 row_ror:8 row_mask:0xf bank_mask:0xf
    v_fma_f32 v60, v60, v23, v20
    s_mov_b64 exec, s[88:89]
    v_cvt_pk_bf16_f32 v60, v60, v60
    global_store_short v18, v60, s[30:31] nt
    s_branch L_end
L_roleS:
    s_cmp_lg_u32 s40, 0
    s_cbranch_scc1 L_end
    v_mov_b32 v6, s32
    s_load_dword s53, s[34:35], 256
L_nc_16:
    s_waitcnt lgkmcnt(0)
    s_sub_u32 s53, s53, s32
    s_cmp_gt_u32 s53, 1
    s_cbranch_scc1 L_nc_16_r
    s_lshl_b32 s48, s41, 2
    s_add_u32 s48, s48, 32768
    v_and_b32 v4, 31, v0
    v_lshl_add_u32 v4, v4, 7, s48
    v_lshrrev_b32 v5, 5, v0
    v_xor_b32 v5, s53, v5
    v_lshl_add_u32 v4, v5, 13, v4
    v_add_u32 v5, 4096, v4
    s_lshl_b32 s48, s41, 15
    s_add_u32 s48, s48, 1048576
    v_lshl_add_u32 v2, v0, 7, s48
    s_lshl_b32 s48, s41, 12
    s_add_u32 s48, s48, 1343488
    v_lshl_add_u32 v3, v0, 6, s48
    s_mov_b32 s50, 0x11111111
    s_mov_b32 s51, 0x11111111
    s_lshl_b32 s48, s41, 7
    s_add_u32 s48, s48, 1318912
    v_lshrrev_b32 v7, 1, v0
    v_lshl_add_u32 v7, v7, 2, s48
    v_and_b32 v9, 1, v0
    v_cmp_eq_u32 vcc, 1, v9
    s_nop 1
    v_cndmask_b32 v2, v2, v7, vcc
    s_mov_b32 s52, 0xbbbbbbbb
    s_mov_b32 s53, 0xbbbbbbbb
    s_cmp_eq_u32 s3, 0
    s_cselect_b32 s54, 200, 0
    s_mov_b64 vcc, s[52:53]
L_s_a:
    s_mov_b64 exec, vcc
    global_load_dword v8, v2, s[34:35] nt
    s_waitcnt vmcnt(0)
    v_cmp_ne_u32_sdwa vcc, v8, s96 src0_sel:BYTE_0 src1_sel:DWORD
    s_mov_b64 exec, -1
    s_cbranch_vccz L_s_a_ok
    s_sub_u32 s54, s54, 1
    s_cbranch_scc0 L_s_a
    s_mov_b32 s54, 0
    s_and_b64 vcc, vcc, s[50:51]
    s_cbranch_scc0 L_s_a_ok
    v_xor_b32 v2, 524288, v2
    s_sub_u32 s39, s39, 1
    s_cbranch_scc0 L_s_a
L_s_a_ok:
    global_store_dword v4, v6, s[34:35] sc1
    s_cmp_eq_u32 s3, 0
    s_cselect_b32 s54, 200, 0
    s_mov_b64 vcc, -1
L_s_b:
    s_mov_b64 exec, vcc
    global_load_dword v8, v3, s[34:35] nt
    s_waitcnt vmcnt(0)
    v_cmp_ne_u32_sdwa vcc, v8, s96 src0_sel:BYTE_0 src1_sel:DWORD
    s_mov_b64 exec, -1
    s_cbranch_vccz L_s_b_ok
    s_sub_u32 s54, s54, 1
    s_cbranch_scc0 L_s_b
    s_mov_b32 s54, 0
    v_xor_b32 v3, 524288, v3
    s_sub_u32 s39, s39, 1
    s_cbranch_scc0 L_s_b
L_s_b_ok:
    s_sleep 8
    global_store_dword v5, v6, s[34:35] sc1
    s_branch L_end
L_C1:
    v_mov_b32 v6, 0
    v_lshlrev_b32 v5, 2, v0
    v_add_u32 v5, 132352, v5
    ds_write_b32 v5, v6
    s_and_b32 s47, s40, 3
    s_and_b32 s52, s46, 1
    s_lshr_b32 s53, s46, 1
    s_and_b32 s54, s40, 1
    v_mov_b32 v8, 132352
    s_lshl_b32 s48, s40, 2
    s_add_u32 s48, s48, 132352
    v_mov_b32 v7, s48
    v_mov_b32 v31, 1
    s_waitcnt lgkmcnt(0)
    s_load_dword s32, s[34:35], 0
    s_barrier
    s_getreg_b32 s3, hwreg(HW_REG_XCC_ID, 0, 4)
    s_xor_b32 s3, s3, s41
    s_lshl_b32 s55, s40, 13
    v_and_b32 v1, 15, v0
    v_bfe_u32 v9, v0, 2, 2
    v_and_b32 v3, 3, v0
    v_lshl_add_u32 v3, v9, 3, v3
    v_lshlrev_b32 v3, 8, v3
    v_and_b32 v4, 7, v0
    v_bfe_u32 v5, v0, 3, 1
    v_lshl_add_u32 v4, v4, 1, v5
    v_lshlrev_b32 v5, 2, v2
    v_xor_b32 v4, v4, v5
    v_lshl_add_u32 v3, v4, 4, v3
    v_add_u32 v20, s55, v3
    v_xor_b32 v21, 16, v20
    v_xor_b32 v22, 32, v20
    v_xor_b32 v23, 48, v20
    v_lshrrev_b32 v104, 4, v0
    v_bfe_u32 v12, v0, 2, 2
    v_lshl_add_u32 v104, v104, 3, v12
    v_mul_u32_u24 v104, 256, v104
    v_bfe_u32 v13, v0, 4, 1
    v_lshl_add_u32 v13, v13, 2, v12
    v_xor_b32 v13, s40, v13
    v_lshl_add_u32 v104, v13, 5, v104
    v_and_b32 v12, 3, v0
    v_lshl_add_u32 v104, v12, 3, v104
    v_add_u32 v104, 65536, v104
    v_lshrrev_b32 v12, 5, v0
    v_lshlrev_b32 v12, 4, v12
    v_xor_b32 v104, v12, v104
    s_lshl_b32 s48, s51, 13
    s_lshl_b32 s49, s40, 10
    s_add_u32 s48, s48, s49
    s_add_u32 s48, s48, 131072
    v_lshl_add_u32 v4, v0, 4, s48
    v_and_b32 v6, 1, v0
    v_lshl_add_u32 v6, v6, 2, v2
    v_lshlrev_b32 v6, 1, v6
    v_bfe_u32 v3, v0, 1, 2
    v_lshl_add_u32 v6, v3, 8, v6
    v_bfe_u32 v3, v0, 3, 1
    v_lshl_add_u32 v6, v3, 4, v6
    s_lshr_b32 s100, s40, 1
    s_lshl_b32 s48, s54, 5
    s_lshl_b32 s49, s100, 6
    s_add_u32 s48, s48, s49
    s_add_u32 s48, s48, 131072
    v_add_u32 v6, s48, v6
    v_lshlrev_b32 v3, 6, v9
    v_lshl_add_u32 v3, v2, 4, v3
    v_add_u32 v3, 135168, v3
    v_lshlrev_b32 v5, 2, v9
    v_lshl_add_u32 v5, v2, 4, v5
    v_and_b32 v9, 3, v0
    v_lshl_add_u32 v5, v9, 6, v5
    s_lshl_b32 s48, s40, 8
    s_add_u32 s48, s48, 135168
    v_add_u32 v5, s48, v5
    v_lshlrev_b32 v10, 6, v9
    v_lshl_add_u32 v10, v2, 4, v10
    v_add_u32 v10, 131072, v10
    v_and_b32 v105, 60, v0
    v_lshl_add_u32 v105, v9, 6, v105
    s_mul_i32 s48, s40, 272
    s_add_u32 s48, s48, 137216
    v_add_u32 v105, s48, v105
    v_and_b32 v106, 7, v0
    v_mul_u32_u24 v106, 272, v106
    v_lshl_add_u32 v106, v2, 6, v106
    v_and_b32 v107, 8, v0
    v_lshl_add_u32 v106, v107, 2, v106
    v_add_u32 v106, 137216, v106
    s_lshl_b32 s48, s40, 2
    s_add_u32 s48, s48, 132096
    v_lshl_add_u32 v9, v9, 6, s48
    v_and_b32 v11, 7, v0
    v_lshlrev_b32 v11, 2, v11
    v_lshl_add_u32 v11, v2, 6, v11
    v_add_u32 v11, 132096, v11
    s_lshl_b32 s100, s41, 6
    s_add_u32 s100, s100, s46
    s_lshl_b32 s48, s100, 4
    s_add_u32 s48, s48, 1310720
    v_lshl_add_u32 v29, v2, 8, s48
    s_lshl_b32 s48, s100, 9
    s_lshl_b32 s49, s40, 6
    s_add_u32 s48, s48, s49
    s_add_u32 s48, s48, 1048576
    v_lshlrev_b32 v1, 2, v1
    v_lshl_add_u32 v1, v2, 13, v1
    v_add_u32 v1, s48, v1
    s_waitcnt lgkmcnt(0)
    s_mov_b32 s37, 0xffff0000
    s_mov_b32 s39, 100000
    s_mov_b32 s44, 0x00030003
    s_mov_b32 s45, 0x00030003
    s_add_u32 s32, s32, 0x01010101
    s_mov_b32 s33, s32
    s_bfe_u32 s96, s32, 0x80000
    s_bfe_u32 s97, s32, 0x80008
    s_bfe_u32 s98, s32, 0x80010
    s_bfe_u32 s99, s32, 0x80018
    v_and_b32 v12, 3, v0
    v_lshlrev_b32 v12, 3, v12
    v_mov_b32 v167, s32
    v_bfe_u32 v159, v167, v12, 8
    s_lshl3_add_u32 s48, s2, s40
    s_cmp_eq_u32 s48, 2041
    s_cbranch_scc1 L_det
    s_cmp_lg_u32 s40, 0
    s_cbranch_scc1 L_c_k
    s_lshl_b32 s101, s41, 11
    s_lshl_b32 s49, s46, 7
    s_add_u32 s101, s101, s49
    s_add_u32 s101, s101, 458752
    s_load_dword s80, s[34:35], s101
    s_lshl_b32 s38, s41, 11
    s_add_u32 s38, s38, 65536
    s_lshl_b32 s48, s46, 7
    s_add_u32 s48, s48, s38
    v_mov_b32 v12, s48
    v_cmp_eq_u32 vcc, 1, v0
    s_nop 1
    v_cndmask_b32 v12, v29, v12, vcc
    v_and_b32 v13, 3, v0
    v_lshl_add_u32 v13, v13, 7, v1
    v_and_b32 v14, 12, v0
    v_cmp_eq_u32 vcc, 4, v14
    s_nop 1
    v_cndmask_b32 v12, v12, v13, vcc
    s_lshl_b32 s48, s41, 7
    s_add_u32 s48, s48, 1318912
    v_writelane_b32 v12, s48, 2
    s_mov_b32 exec_lo, 0x00f100f7
    s_mov_b32 exec_hi, 0x00f100f1
    global_load_dword v27, v12, s[34:35] sc1
    s_mov_b64 exec, -1
L_c_k:
    s_cmp_lg_u32 s40, 0
    s_cbranch_scc1 L_c_w
    s_sleep 40
    s_add_u32 s43, s38, 2048
    s_cmp_lg_u32 s3, 0
    s_cbranch_scc1 L_x_slow
L_x_lp:
    s_load_dwordx16 s[80:95], s[34:35], s38
    s_sleep 1
    s_add_u32 s38, s38, 64
    s_cmp_eq_u32 s38, s43
    s_cbranch_scc1 L_x_slow
    s_waitcnt lgkmcnt(0)
    s_cmp_eq_u64 s[80:81], s[32:33]
    s_cbranch_scc0 L_x_lp
    s_cmp_eq_u64 s[82:83], s[32:33]
    s_cbranch_scc0 L_x_lp
    s_cmp_eq_u64 s[84:85], s[32:33]
    s_cbranch_scc0 L_x_lp
    s_cmp_eq_u64 s[86:87], s[32:33]
    s_cbranch_scc0 L_x_lp
    s_cmp_eq_u64 s[88:89], s[32:33]
    s_cbranch_scc0 L_x_lp
    s_cmp_eq_u64 s[90:91], s[32:33]
    s_cbranch_scc0 L_x_lp
    s_cmp_eq_u64 s[92:93], s[32:33]
    s_cbranch_scc0 L_x_lp
    s_cmp_eq_u64 s[94:95], s[32:33]
    s_cbranch_scc0 L_x_lp
    s_branch L_x_go
L_x_slow:
    s_waitcnt lgkmcnt(0)
    s_not_b32 s80, s32
L_fw_17:
    s_sub_u32 s39, s39, 1
    s_cbranch_scc1 L_end
    s_load_dwordx16 s[80:95], s[34:35], s101 glc
    s_waitcnt lgkmcnt(0)
    s_cmp_eq_u64 s[80:81], s[32:33]
    s_cbranch_scc0 L_fw_17
    s_cmp_eq_u64 s[82:83], s[32:33]
    s_cbranch_scc0 L_fw_17
    s_cmp_eq_u64 s[84:85], s[32:33]
    s_cbranch_scc0 L_fw_17
    s_cmp_eq_u64 s[86:87], s[32:33]
    s_cbranch_scc0 L_fw_17
    s_cmp_eq_u64 s[88:89], s[32:33]
    s_cbranch_scc0 L_fw_17
    s_cmp_eq_u64 s[90:91], s[32:33]
    s_cbranch_scc0 L_fw_17
    s_cmp_eq_u64 s[92:93], s[32:33]
    s_cbranch_scc0 L_fw_17
    s_cmp_eq_u64 s[94:95], s[32:33]
    s_cbranch_scc0 L_fw_17
    s_mov_b32 s3, 1
L_x_go:
    s_add_u32 s48, s3, 1
    v_mov_b32 v12, s48
    ds_write_b32 v8, v12 offset:192
L_c_w:
L_c_gs:
    ds_read_b32 v12, v8 offset:192
    s_waitcnt lgkmcnt(0)
    v_cmp_eq_u32 vcc, 0, v12
    s_cbranch_vccz L_c_gs_ok
    s_sub_u32 s39, s39, 1
    s_cbranch_scc0 L_c_gs
    s_branch L_end
L_c_gs_ok:
    v_readfirstlane_b32 s3, v12
    s_setprio 3
    s_sub_u32 s3, s3, 1
    global_load_dwordx4 v[12:15], v4, s[34:35] sc1
    s_mov_b64 exec, 1
    ds_add_u32 v8, v31 offset:208
    s_mov_b64 exec, -1
L_c_ks:
    ds_read_b32 v16, v7 offset:0
    s_sleep 1
    s_waitcnt lgkmcnt(0)
    v_cmp_eq_u32 vcc, 0, v16
    s_cbranch_vccz L_c_ks_ok
    s_sub_u32 s39, s39, 1
    s_cbranch_scc0 L_c_ks
    s_branch L_end
L_c_ks_ok:
    ds_read_b128 v[32:35], v20 offset:0
    ds_read_b128 v[36:39], v21 offset:0
    ds_read_b128 v[40:43], v22 offset:0
    ds_read_b128 v[44:47], v23 offset:0
    ds_read_b128 v[48:51], v20 offset:1024
    ds_read_b128 v[52:55], v21 offset:1024
    ds_read_b128 v[56:59], v22 offset:1024
    ds_read_b128 v[60:63], v23 offset:1024
    ds_read_b128 v[116:119], v8 offset:32
    ds_read_b64_tr_b16 v[64:65], v104 offset:0
    ds_read_b64_tr_b16 v[66:67], v104 offset:1024
    ds_read_b64_tr_b16 v[68:69], v104 offset:8192
    ds_read_b64_tr_b16 v[70:71], v104 offset:9216
    ds_read_b64_tr_b16 v[72:73], v104 offset:16384
    ds_read_b64_tr_b16 v[74:75], v104 offset:17408
    ds_read_b64_tr_b16 v[76:77], v104 offset:24576
    ds_read_b64_tr_b16 v[78:79], v104 offset:25600
    s_waitcnt lgkmcnt(0)
    v_and_b32 v116, v116, v119
    v_bitop3_b32 v116, v116, v117, v118 bitop3:0x80
    s_nop 0
    v_readfirstlane_b32 s84, v116
    s_branch L_a_chk
L_a_poll:
    global_load_dwordx4 v[12:15], v4, s[34:35] sc1
L_a_chk:
    s_waitcnt vmcnt(0)
    v_xor_b32 v12, s96, v12
    v_xor_b32 v13, s97, v13
    v_xor_b32 v14, s98, v14
    v_xor_b32 v15, s99, v15
    v_or3_b32 v24, v12, v13, v14
    v_or_b32 v24, v24, v15
    v_cmp_ne_u32_sdwa vcc, v24, 0 src0_sel:BYTE_0 src1_sel:DWORD
    s_cbranch_vccnz L_rt_18
    v_permlane32_swap_b32 v12, v14
    v_permlane32_swap_b32 v13, v15
    v_add_f32 v12, v12, v14
    v_add_f32 v13, v13, v15
    s_nop 1
    v_permlane16_swap_b32 v12, v13
    v_add_f32 v12, v12, v13
    v_cvt_pk_bf16_f32 v12, v12, v12
    ds_write_b16 v6, v12
    s_mov_b64 exec, 1
    ds_add_u32 v8, v31 offset:64
    s_mov_b64 exec, -1
L_a_qs:
    ds_read_b32 v112, v8 offset:64
    s_sub_u32 s39, s39, 1
    s_cbranch_scc1 L_end
    s_waitcnt lgkmcnt(0)
    v_cmp_ne_u32 vcc, 8, v112
    s_cbranch_vccnz L_a_qs
    ds_read_b128 v[12:15], v10 offset:0
    ds_read_b128 v[16:19], v10 offset:256
    ds_read_b128 v[20:23], v10 offset:512
    ds_read_b128 v[24:27], v10 offset:768
    s_waitcnt lgkmcnt(3)
    v_mfma_f32_16x16x32_bf16 v[96:99], v[32:35], v[12:15], 0
    v_mfma_f32_16x16x32_bf16 v[100:103], v[48:51], v[12:15], 0
    s_waitcnt lgkmcnt(2)
    v_mfma_f32_16x16x32_bf16 v[96:99], v[36:39], v[16:19], v[96:99]
    v_mfma_f32_16x16x32_bf16 v[100:103], v[52:55], v[16:19], v[100:103]
    s_waitcnt lgkmcnt(1)
    v_mfma_f32_16x16x32_bf16 v[96:99], v[40:43], v[20:23], v[96:99]
    v_mfma_f32_16x16x32_bf16 v[100:103], v[56:59], v[20:23], v[100:103]
    s_waitcnt lgkmcnt(0)
    v_mfma_f32_16x16x32_bf16 v[96:99], v[44:47], v[24:27], v[96:99]
    v_mfma_f32_16x16x32_bf16 v[100:103], v[60:63], v[24:27], v[100:103]
    ds_read_b128 v[112:115], v8 offset:32
    ds_read_b128 v[116:119], v8 offset:48
    s_cmp_lg_u32 s84, 0
    s_cbranch_scc1 L_c_h
    ds_read_b64_tr_b16 v[64:65], v104 offset:0
    ds_read_b64_tr_b16 v[66:67], v104 offset:1024
    ds_read_b64_tr_b16 v[68:69], v104 offset:8192
    ds_read_b64_tr_b16 v[70:71], v104 offset:9216
    ds_read_b64_tr_b16 v[72:73], v104 offset:16384
    ds_read_b64_tr_b16 v[74:75], v104 offset:17408
    ds_read_b64_tr_b16 v[76:77], v104 offset:24576
    ds_read_b64_tr_b16 v[78:79], v104 offset:25600
L_c_h:
    ds_read_b64_tr_b16 v[80:81], v104 offset:32768
    ds_read_b64_tr_b16 v[82:83], v104 offset:33792
    ds_read_b64_tr_b16 v[84:85], v104 offset:40960
    ds_read_b64_tr_b16 v[86:87], v104 offset:41984
    ds_read_b64_tr_b16 v[88:89], v104 offset:49152
    ds_read_b64_tr_b16 v[90:91], v104 offset:50176
    ds_read_b64_tr_b16 v[92:93], v104 offset:57344
    ds_read_b64_tr_b16 v[94:95], v104 offset:58368
    s_mov_b32 s14, 0x3db504f3
    v_mov_b32_dpp v96, v98 quad_perm:[0,1,2,3] row_mask:0xf bank_mask:2
    v_mov_b32_dpp v97, v99 quad_perm:[0,1,2,3] row_mask:0xf bank_mask:2
    s_nop 0
    v_mov_b32_dpp v96, v100 quad_perm:[0,1,2,3] row_mask:0xf bank_mask:4
    v_mov_b32_dpp v97, v101 quad_perm:[0,1,2,3] row_mask:0xf bank_mask:4
    s_nop 0
    v_mov_b32_dpp v96, v102 quad_perm:[0,1,2,3] row_mask:0xf bank_mask:8
    v_mov_b32_dpp v97, v103 quad_perm:[0,1,2,3] row_mask:0xf bank_mask:8
    v_cvt_pk_bf16_f32 v97, v96, v97
    v_lshlrev_b32 v96, 16, v97
    v_and_b32 v97, s37, v97
    v_pk_mul_f32 v[96:97], v[96:97], s[14:15] op_sel_hi:[1,0]
    v_cvt_pk_bf16_f32 v97, v96, v97
    v_lshlrev_b32 v96, 16, v97
    v_and_b32 v97, s37, v97
    v_max_f32 v12, v96, v97
    s_waitcnt lgkmcnt(8)
    v_bitop3_b32 v16, v112, v113, v114 bitop3:0x80
    v_max_f32_dpp v12, v12, v12 row_ror:4 row_mask:0xf bank_mask:0xf
    v_bitop3_b32 v17, v115, v116, v117 bitop3:0x80
    v_and_b32 v18, v118, v119
    v_max_f32_dpp v12, v12, v12 row_ror:8 row_mask:0xf bank_mask:0xf
    v_mov_b32 v13, v12
    v_and_b32 v16, v16, v17
    v_readfirstlane_b32 s85, v18
    v_permlane16_swap_b32 v12, v13
    v_max_f32 v12, v12, v13
    v_mov_b32 v13, v12
    v_readfirstlane_b32 s84, v16
    s_mov_b32 s14, 0x3fb8aa3b
    v_permlane32_swap_b32 v12, v13
    v_max_f32 v12, v12, v13
    v_pk_add_f32 v[96:97], v[96:97], v[12:13] op_sel_hi:[1,0] neg_lo:[0,1] neg_hi:[0,1]
    ds_write_b32 v9, v12
    v_pk_mul_f32 v[96:97], v[96:97], s[14:15] op_sel_hi:[1,0]
    v_exp_f32 v96, v96
    v_exp_f32 v97, v97
    s_nop 0
    v_cvt_pk_bf16_f32 v14, v96, v97
    v_add_f32 v13, v96, v97
    ds_write_b32 v5, v14
    ds_write_b32 v105, v13
    s_mov_b64 exec, 1
    ds_add_u32 v8, v31 offset:96
    s_mov_b64 exec, -1
L_a_ms:
    ds_read_b32 v12, v8 offset:96
    s_sub_u32 s39, s39, 1
    s_cbranch_scc1 L_end
    s_waitcnt lgkmcnt(0)
    v_cmp_ne_u32 vcc, 8, v12
    s_cbranch_vccnz L_a_ms
    s_cmp_eq_u32 s40, 0
    s_cbranch_scc1 L_c_l0
L_c_l1:
    ds_read_b32 v96, v11
    ds_read_b128 v[120:123], v3 offset:0
    ds_read_b128 v[124:127], v3 offset:256
    ds_read_b128 v[128:131], v3 offset:512
    ds_read_b128 v[132:135], v3 offset:768
    ds_read_b128 v[136:139], v3 offset:1024
    ds_read_b128 v[140:143], v3 offset:1280
    ds_read_b128 v[144:147], v3 offset:1536
    ds_read_b128 v[148:151], v3 offset:1792
    s_cmp_eq_u32 s84, 0
    s_cbranch_scc1 L_c_slow
    s_waitcnt lgkmcnt(7)
    v_mfma_f32_16x16x32_bf16 v[32:35], v[120:123], v[64:67], 0
    v_max_f32_dpp v156, v96, v96 quad_perm:[1,0,3,2] row_mask:0xf bank_mask:0xf
    s_waitcnt lgkmcnt(6)
    v_mfma_f32_16x16x32_bf16 v[36:39], v[124:127], v[68:71], 0
    v_max_f32_dpp v156, v156, v156 quad_perm:[2,3,0,1] row_mask:0xf bank_mask:0xf
    s_waitcnt lgkmcnt(5)
    v_mfma_f32_16x16x32_bf16 v[40:43], v[128:131], v[72:75], 0
    v_max_f32_dpp v156, v156, v156 row_half_mirror row_mask:0xf bank_mask:0xf
    s_waitcnt lgkmcnt(4)
    v_mfma_f32_16x16x32_bf16 v[44:47], v[132:135], v[76:79], 0
    v_sub_f32 v96, v96, v156
    s_waitcnt lgkmcnt(3)
    v_mfma_f32_16x16x32_bf16 v[48:51], v[136:139], v[80:83], 0
    v_mul_f32 v96, 0x3fb8aa3b, v96
    s_waitcnt lgkmcnt(2)
    v_mfma_f32_16x16x32_bf16 v[52:55], v[140:143], v[84:87], 0
    v_exp_f32 v96, v96
    s_cmp_eq_u32 s85, 0
    s_cbranch_scc1 L_c_semi
    s_waitcnt lgkmcnt(1)
    v_mfma_f32_16x16x32_bf16 v[56:59], v[144:147], v[88:91], 0
    s_waitcnt lgkmcnt(0)
    v_mfma_f32_16x16x32_bf16 v[60:63], v[148:151], v[92:95], 0
    s_cmp_lg_u32 s40, 0
    s_cbranch_scc1 L_sp_19
    v_pk_add_f32 v[100:101], v[100:101], v[108:109]
    v_pk_add_f32 v[102:103], v[102:103], v[110:111]
    v_mov_b32 v158, s32
    v_pk_add_f32 v[100:101], v[100:101], v[102:103]
    v_add_f32 v157, v100, v101
    v_mul_f32 v157, v96, v157
    s_nop 1
    v_add_f32_dpp v157, v157, v157 quad_perm:[1,0,3,2] row_mask:0xf bank_mask:0xf
    s_nop 1
    v_add_f32_dpp v157, v157, v157 quad_perm:[2,3,0,1] row_mask:0xf bank_mask:0xf
    s_nop 1
    v_add_f32_dpp v157, v157, v157 row_ror:4 row_mask:0xf bank_mask:0xf
    s_nop 1
    v_add_f32_dpp v157, v157, v157 row_ror:8 row_mask:0xf bank_mask:0xf
    s_mov_b32 exec_lo, 0x00010001
    s_mov_b32 exec_hi, 0x00010001
    global_store_dwordx3 v29, v[156:158], s[34:35]
    s_cmp_eq_u32 s3, 0
    s_cbranch_scc1 L_sp_19_ns
    v_xor_b32 v29, 524288, v29
    global_store_dwordx3 v29, v[156:158], s[34:35] sc1
L_sp_19_ns:
    s_mov_b64 exec, -1
L_sp_19:
    v_mul_f32_dpp v152, v96, v32 row_newbcast:0 row_mask:0xf bank_mask:0xf
    v_mul_f32_dpp v153, v96, v36 row_newbcast:1 row_mask:0xf bank_mask:0xf
    v_mul_f32_dpp v154, v96, v40 row_newbcast:2 row_mask:0xf bank_mask:0xf
    v_fmac_f32_dpp v152, v96, v44 row_newbcast:3 row_mask:0xf bank_mask:0xf
    v_fmac_f32_dpp v153, v96, v48 row_newbcast:4 row_mask:0xf bank_mask:0xf
    v_fmac_f32_dpp v154, v96, v52 row_newbcast:5 row_mask:0xf bank_mask:0xf
    v_fmac_f32_dpp v152, v96, v56 row_newbcast:6 row_mask:0xf bank_mask:0xf
    v_fmac_f32_dpp v153, v96, v60 row_newbcast:7 row_mask:0xf bank_mask:0xf
    s_branch L_c_pub
L_c_semi:
    ds_read_b64 v[14:15], v8 offset:56
    ds_read_b64_tr_b16 v[88:89], v104 offset:49152
    ds_read_b64_tr_b16 v[90:91], v104 offset:50176
    ds_read_b64_tr_b16 v[92:93], v104 offset:57344
    ds_read_b64_tr_b16 v[94:95], v104 offset:58368
    s_cmp_lg_u32 s40, 0
    s_cbranch_scc1 L_sp_20
    v_pk_add_f32 v[100:101], v[100:101], v[108:109]
    v_pk_add_f32 v[102:103], v[102:103], v[110:111]
    v_mov_b32 v158, s32
    v_pk_add_f32 v[100:101], v[100:101], v[102:103]
    v_add_f32 v157, v100, v101
    v_mul_f32 v157, v96, v157
    s_nop 1
    v_add_f32_dpp v157, v157, v157 quad_perm:[1,0,3,2] row_mask:0xf bank_mask:0xf
    s_nop 1
    v_add_f32_dpp v157, v157, v157 quad_perm:[2,3,0,1] row_mask:0xf bank_mask:0xf
    s_nop 1
    v_add_f32_dpp v157, v157, v157 row_ror:4 row_mask:0xf bank_mask:0xf
    s_nop 1
    v_add_f32_dpp v157, v157, v157 row_ror:8 row_mask:0xf bank_mask:0xf
    s_mov_b32 exec_lo, 0x00010001
    s_mov_b32 exec_hi, 0x00010001
    global_store_dwordx3 v29, v[156:158], s[34:35]
    s_cmp_eq_u32 s3, 0
    s_cbranch_scc1 L_sp_20_ns
    v_xor_b32 v29, 524288, v29
    global_store_dwordx3 v29, v[156:158], s[34:35] sc1
L_sp_20_ns:
    s_mov_b64 exec, -1
L_sp_20:
    v_mul_f32_dpp v152, v96, v32 row_newbcast:0 row_mask:0xf bank_mask:0xf
    v_mul_f32_dpp v153, v96, v36 row_newbcast:1 row_mask:0xf bank_mask:0xf
    v_mul_f32_dpp v154, v96, v40 row_newbcast:2 row_mask:0xf bank_mask:0xf
    v_fmac_f32_dpp v152, v96, v44 row_newbcast:3 row_mask:0xf bank_mask:0xf
    v_fmac_f32_dpp v153, v96, v48 row_newbcast:4 row_mask:0xf bank_mask:0xf
    v_fmac_f32_dpp v154, v96, v52 row_newbcast:5 row_mask:0xf bank_mask:0xf
    s_branch L_c_s2
L_c_s1:
    ds_read_b64 v[14:15], v8 offset:56
    ds_read_b64_tr_b16 v[88:89], v104 offset:49152
    ds_read_b64_tr_b16 v[90:91], v104 offset:50176
    ds_read_b64_tr_b16 v[92:93], v104 offset:57344
    ds_read_b64_tr_b16 v[94:95], v104 offset:58368
    s_sub_u32 s39, s39, 1
    s_cbranch_scc1 L_end
L_c_s2:
    s_waitcnt lgkmcnt(0)
    v_and_b32 v14, v14, v15
    v_cmp_eq_u32 vcc, 0, v14
    s_cbranch_vccnz L_c_s1
    v_mfma_f32_16x16x32_bf16 v[56:59], v[144:147], v[88:91], 0
    v_mfma_f32_16x16x32_bf16 v[60:63], v[148:151], v[92:95], 0
    s_nop 6
    v_fmac_f32_dpp v152, v96, v56 row_newbcast:6 row_mask:0xf bank_mask:0xf
    v_fmac_f32_dpp v153, v96, v60 row_newbcast:7 row_mask:0xf bank_mask:0xf
    s_branch L_c_pub
L_c_slow:
    s_waitcnt lgkmcnt(0)
    v_max_f32_dpp v156, v96, v96 quad_perm:[1,0,3,2] row_mask:0xf bank_mask:0xf
    s_nop 1
    v_max_f32_dpp v156, v156, v156 quad_perm:[2,3,0,1] row_mask:0xf bank_mask:0xf
    s_nop 1
    v_max_f32_dpp v156, v156, v156 row_half_mirror row_mask:0xf bank_mask:0xf
    v_sub_f32 v96, v96, v156
    v_mul_f32 v96, 0x3fb8aa3b, v96
    v_exp_f32 v96, v96
    s_cmp_lg_u32 s40, 0
    s_cbranch_scc1 L_sp_21
    v_pk_add_f32 v[100:101], v[100:101], v[108:109]
    v_pk_add_f32 v[102:103], v[102:103], v[110:111]
    v_mov_b32 v158, s32
    v_pk_add_f32 v[100:101], v[100:101], v[102:103]
    v_add_f32 v157, v100, v101
    v_mul_f32 v157, v96, v157
    s_nop 1
    v_add_f32_dpp v157, v157, v157 quad_perm:[1,0,3,2] row_mask:0xf bank_mask:0xf
    s_nop 1
    v_add_f32_dpp v157, v157, v157 quad_perm:[2,3,0,1] row_mask:0xf bank_mask:0xf
    s_nop 1
    v_add_f32_dpp v157, v157, v157 row_ror:4 row_mask:0xf bank_mask:0xf
    s_nop 1
    v_add_f32_dpp v157, v157, v157 row_ror:8 row_mask:0xf bank_mask:0xf
    s_mov_b32 exec_lo, 0x00010001
    s_mov_b32 exec_hi, 0x00010001
    global_store_dwordx3 v29, v[156:158], s[34:35]
    s_cmp_eq_u32 s3, 0
    s_cbranch_scc1 L_sp_21_ns
    v_xor_b32 v29, 524288, v29
    global_store_dwordx3 v29, v[156:158], s[34:35] sc1
L_sp_21_ns:
    s_mov_b64 exec, -1
L_sp_21:
    v_and_b32 v112, v112, v113
    v_and_b32 v114, v114, v115
    v_and_b32 v116, v116, v117
    v_and_b32 v118, v118, v119
    v_readfirstlane_b32 s80, v112
    v_readfirstlane_b32 s81, v114
    v_readfirstlane_b32 s82, v116
    v_readfirstlane_b32 s83, v118
    s_cmp_lg_u32 s80, 0
    s_cbranch_scc1 L_c_v0
L_c_w0:
    ds_read_b64 v[12:13], v8 offset:32
    s_sub_u32 s39, s39, 1
    s_cbranch_scc1 L_end
    s_waitcnt lgkmcnt(0)
    v_and_b32 v12, v12, v13
    v_cmp_eq_u32 vcc, 0, v12
    s_cbranch_vccnz L_c_w0
    ds_read_b64_tr_b16 v[64:65], v104 offset:0
    ds_read_b64_tr_b16 v[66:67], v104 offset:1024
    ds_read_b64_tr_b16 v[68:69], v104 offset:8192
    ds_read_b64_tr_b16 v[70:71], v104 offset:9216
    s_waitcnt lgkmcnt(0)
L_c_v0:
    v_mfma_f32_16x16x32_bf16 v[32:35], v[120:123], v[64:67], 0
    v_mfma_f32_16x16x32_bf16 v[36:39], v[124:127], v[68:71], 0
    s_nop 6
    v_mul_f32_dpp v152, v96, v32 row_newbcast:0 row_mask:0xf bank_mask:0xf
    v_mul_f32_dpp v153, v96, v36 row_newbcast:1 row_mask:0xf bank_mask:0xf
    s_cmp_lg_u32 s81, 0
    s_cbranch_scc1 L_c_v1
L_c_w1:
    ds_read_b64 v[12:13], v8 offset:40
    s_sub_u32 s39, s39, 1
    s_cbranch_scc1 L_end
    s_waitcnt lgkmcnt(0)
    v_and_b32 v12, v12, v13
    v_cmp_eq_u32 vcc, 0, v12
    s_cbranch_vccnz L_c_w1
    ds_read_b64_tr_b16 v[72:73], v104 offset:16384
    ds_read_b64_tr_b16 v[74:75], v104 offset:17408
    ds_read_b64_tr_b16 v[76:77], v104 offset:24576
    ds_read_b64_tr_b16 v[78:79], v104 offset:25600
    s_waitcnt lgkmcnt(0)
L_c_v1:
    v_mfma_f32_16x16x32_bf16 v[40:43], v[128:131], v[72:75], 0
    v_mfma_f32_16x16x32_bf16 v[44:47], v[132:135], v[76:79], 0
    s_nop 6
    v_mul_f32_dpp v154, v96, v40 row_newbcast:2 row_mask:0xf bank_mask:0xf
    v_fmac_f32_dpp v152, v96, v44 row_newbcast:3 row_mask:0xf bank_mask:0xf
    s_cmp_lg_u32 s82, 0
    s_cbranch_scc1 L_c_v2
L_c_w2:
    ds_read_b64 v[12:13], v8 offset:48
    s_sub_u32 s39, s39, 1
    s_cbranch_scc1 L_end
    s_waitcnt lgkmcnt(0)
    v_and_b32 v12, v12, v13
    v_cmp_eq_u32 vcc, 0, v12
    s_cbranch_vccnz L_c_w2
    ds_read_b64_tr_b16 v[80:81], v104 offset:32768
    ds_read_b64_tr_b16 v[82:83], v104 offset:33792
    ds_read_b64_tr_b16 v[84:85], v104 offset:40960
    ds_read_b64_tr_b16 v[86:87], v104 offset:41984
    s_waitcnt lgkmcnt(0)
L_c_v2:
    v_mfma_f32_16x16x32_bf16 v[48:51], v[136:139], v[80:83], 0
    v_mfma_f32_16x16x32_bf16 v[52:55], v[140:143], v[84:87], 0
    s_nop 6
    v_fmac_f32_dpp v153, v96, v48 row_newbcast:4 row_mask:0xf bank_mask:0xf
    v_fmac_f32_dpp v154, v96, v52 row_newbcast:5 row_mask:0xf bank_mask:0xf
    s_cmp_lg_u32 s83, 0
    s_cbranch_scc1 L_c_v3
L_c_w3:
    ds_read_b64 v[12:13], v8 offset:56
    s_sub_u32 s39, s39, 1
    s_cbranch_scc1 L_end
    s_waitcnt lgkmcnt(0)
    v_and_b32 v12, v12, v13
    v_cmp_eq_u32 vcc, 0, v12
    s_cbranch_vccnz L_c_w3
    ds_read_b64_tr_b16 v[88:89], v104 offset:49152
    ds_read_b64_tr_b16 v[90:91], v104 offset:50176
    ds_read_b64_tr_b16 v[92:93], v104 offset:57344
    ds_read_b64_tr_b16 v[94:95], v104 offset:58368
    s_waitcnt lgkmcnt(0)
L_c_v3:
    v_mfma_f32_16x16x32_bf16 v[56:59], v[144:147], v[88:91], 0
    v_mfma_f32_16x16x32_bf16 v[60:63], v[148:151], v[92:95], 0
    s_nop 6
    v_fmac_f32_dpp v152, v96, v56 row_newbcast:6 row_mask:0xf bank_mask:0xf
    v_fmac_f32_dpp v153, v96, v60 row_newbcast:7 row_mask:0xf bank_mask:0xf
L_c_pub:
    v_add_f32 v154, v154, v152
    v_add_f32 v154, v154, v153
    s_movk_i32 s48, 0xff
    v_bfi_b32 v154, s48, v159, v154
    global_store_dword v1, v154, s[34:35]
    s_setprio 0
    s_cmp_eq_u32 s3, 0
    s_cbranch_scc1 L_c_e
    v_xor_b32 v1, 524288, v1
    global_store_dword v1, v154, s[34:35] sc1
L_c_e:
    s_barrier
    s_cmp_lt_u32 s46, 8
    s_cbranch_scc1 L_red
    s_cmp_eq_u32 s46, 15
    s_cbranch_scc1 L_roleS
    s_sub_u32 s47, s46, 8
    s_lshl_b32 s47, s47, 3
    s_add_u32 s47, s47, s40
    s_mul_i32 s47, s47, 10
    s_min_u32 s47, s47, 502
    v_lshrrev_b32 v3, 2, v0
    v_mul_u32_u24 v3, 3584, v3
    v_and_b32 v4, 3, v0
    v_lshl_add_u32 v3, v4, 7, v3
    s_mul_i32 s54, s41, 448
    s_andn2_b32 s54, s54, 127
    s_mul_i32 s48, s47, 3584
    s_add_u32 s48, s48, s54
    v_add_u32 v3, s48, v3
    s_mov_b32 exec_hi, 0xff
    global_load_dword v5, v3, s[16:17]
L_end:
L_exit:
    s_endpgm
L_rt_1:
    s_sleep 2
    s_sub_u32 s39, s39, 1
    s_cbranch_scc0 L_w_poll
    s_branch L_end
L_nc_2_r:
    s_load_dword s92, s[34:35], 256 glc
    s_sub_u32 s39, s39, 1
    s_cbranch_scc0 L_nc_2
    s_branch L_end
L_rt_3:
    s_sleep 4
    s_sub_u32 s39, s39, 1
    s_cbranch_scc0 L_m_poll1
    s_branch L_end
L_rt_4:
    s_sleep 4
    s_sub_u32 s39, s39, 1
    s_cbranch_scc0 L_m_poll0
    s_branch L_end
L_nc_11_r:
    s_load_dword s53, s[34:35], 256 glc
    s_sub_u32 s39, s39, 1
    s_cbranch_scc0 L_nc_11
    s_branch L_end
L_rt_12:
    s_sleep 2
    s_sub_u32 s39, s39, 1
    s_cbranch_scc0 L_r_poll1
    s_branch L_end
L_rt_13:
    s_sub_u32 s39, s39, 1
    s_cbranch_scc0 L_r_poll2
    s_branch L_end
L_rt_15:
    s_sub_u32 s39, s39, 1
    s_cbranch_scc0 L_r_poll3
    s_branch L_end
L_nc_16_r:
    s_load_dword s53, s[34:35], 256 glc
    s_sub_u32 s39, s39, 1
    s_cbranch_scc0 L_nc_16
    s_branch L_end
L_det:
    s_load_dword s80, s[34:35], 49152
    s_load_dword s81, s[34:35], 57344
    s_mov_b32 s84, 0
    s_mov_b32 s85, 3
L_det1:
    s_waitcnt lgkmcnt(0)
    s_not_b64 s[82:83], s[80:81]
    s_mov_b32 s86, 0
    s_mov_b32 s87, 0
    s_load_dword s82, s[34:35], 49152 glc
L_det2:
    s_add_u32 s86, s86, 0x00400000
    s_cbranch_scc1 L_det3
    s_cmp_eq_u32 s82, s80
    s_cbranch_scc0 L_det2
L_det3:
    s_load_dword s83, s[34:35], 57344 glc
L_det4:
    s_add_u32 s87, s87, 0x00400000
    s_cbranch_scc1 L_det5
    s_cmp_eq_u32 s83, s81
    s_cbranch_scc0 L_det4
L_det5:
    s_cmp_lt_u32 s87, s86
    s_addc_u32 s84, s84, 0
    s_sub_u32 s85, s85, 1
    s_cmp_lg_u32 s85, 0
    s_cbranch_scc1 L_det1
    s_cmp_gt_u32 s84, 1
    s_cselect_b32 s84, 1, 0
    s_getreg_b32 s85, hwreg(HW_REG_XCC_ID, 2, 1)
    s_xor_b32 s84, s84, s85
    s_add_u32 s84, s84, s32
    v_mov_b32 v12, 256
    v_mov_b32 v13, s84
    s_mov_b64 exec, 1
    global_store_dword v12, v13, s[34:35] sc1
    s_mov_b64 exec, -1
    s_waitcnt lgkmcnt(0)
    s_branch L_c_k
L_rt_18:
    s_sub_u32 s39, s39, 1
    s_cbranch_scc0 L_a_poll
    s_branch L_end
L_c_l0:
    ds_read_b128 v[100:103], v106
    ds_read_b128 v[108:111], v106 offset:16
    s_branch L_c_l1
L_last:
    .fill (18432 - (L_last - L_start)) / 4, 4, 0xbf800000
.section .rodata,"a"
.p2align 6
.amdhsa_kernel adaLN_cond__sliding_block_cached__mixer_channel_mlp__decode_kernel
  .amdhsa_next_free_vgpr 168
  .amdhsa_next_free_sgpr 102
  .amdhsa_accum_offset 168
  .amdhsa_group_segment_fixed_size 0
  .amdhsa_kernarg_size 120
  .amdhsa_user_sgpr_count 2
  .amdhsa_user_sgpr_kernarg_segment_ptr 1
  .amdhsa_system_sgpr_workgroup_id_x 1
.end_amdhsa_kernel
```
